```python
import torch

def _softmax(x, axis=-1):
    return torch.softmax(x, dim=axis)
def _gelu(x):
    return torch.nn.functional.gelu(x, approximate="tanh")
def _silu(x):
    return torch.nn.functional.silu(x)
def _sigmoid(x):
    return torch.sigmoid(x)
def _layernorm(x, axis=-1, eps=1e-5):
    m = x.mean(dim=axis, keepdim=True)
    v = x.var(dim=axis, keepdim=True, unbiased=False)
    return (x - m) / torch.sqrt(v + eps)
def _scatter_add(tgt, idx, src, axis=0):
    return tgt.clone().index_add_(axis, idx, src)
def _segment_sum(src, seg, n):
    out = torch.zeros((n,) + src.shape[1:], dtype=src.dtype)
    return out.index_add_(0, seg, src)
def _pad(x, pw):
    flat = tuple(v for pair in reversed(pw) for v in pair)
    return torch.nn.functional.pad(x, flat)

kernel_name = 'parallel_sum__softmax_full_mha__dense_activation_gelu__prompt'

def setup_inputs():

    _w = (lambda a: (lambda t: t.to(torch.bfloat16) if t.is_floating_point() else t)(torch.as_tensor(a)))
    def _A_setup():
        B, S, D = 1, 2048, 512
        return {
            "x": _w((lambda *s: torch.randn(*s, dtype=torch.bfloat16) * 0.05)(B, S, D)),
            "wqkv": _w((lambda *s: torch.randn(*s, dtype=torch.bfloat16) * 0.05)(D, 3 * D)),
            "wo": _w((lambda *s: torch.randn(*s, dtype=torch.bfloat16) * 0.05)(D, D)),
        }
    _A_in = _A_setup()

    def _B_setup():
        B, S, D, F = 1, 2048, 512, 1376
        return {
            "x": _w((lambda *s: torch.randn(*s, dtype=torch.bfloat16) * 0.05)(B, S, D)),
            "w1": _w((lambda *s: torch.randn(*s, dtype=torch.bfloat16) * 0.8)(D, F) * (D ** -0.5)),
            "b1": _w((lambda *s: torch.randn(*s, dtype=torch.bfloat16) * 12.8)(F) * 0.01),
            "w2": _w((lambda *s: torch.randn(*s, dtype=torch.bfloat16) * 0.8)(F, D) * (F ** -0.5)),
            "b2": _w((lambda *s: torch.randn(*s, dtype=torch.bfloat16) * 12.8)(D) * 0.01),
        }
    _B_in = _B_setup()

    return {
        "A_x": _A_in["x"],
        "A_wqkv": _A_in["wqkv"],
        "A_wo": _A_in["wo"],
        "B_x": _B_in["x"],
        "B_w1": _B_in["w1"],
        "B_b1": _B_in["b1"],
        "B_w2": _B_in["w2"],
        "B_b2": _B_in["b2"],
    }

def reference(A_x, A_wqkv, A_wo, B_x, B_w1, B_b1, B_w2, B_b2):
    def _A_ref(x, wqkv, wo):
        B, S, D = x.shape
        H = 32; Dh = D // H
        qkv = (lambda x, *d: x.permute(*d))((x @ wqkv).reshape(B, S, 3, H, Dh), 2, 0, 3, 1, 4)
        q, k, v = qkv[0], qkv[1], qkv[2]
        scale = Dh ** -0.5
        scores = torch.einsum("bhqd,bhkd->bhqk", q, k) * scale
        p = _softmax(scores, axis=-1)
        o = torch.einsum("bhqk,bhkd->bhqd", p, v)
        return (lambda x, *d: x.permute(*d))(o, 0, 2, 1, 3).reshape(B, S, D) @ wo

    def _B_ref(x, w1, b1, w2, b2):
        h = torch.einsum("bsd,df->bsf", x, w1) + b1
        h = _gelu(h)
        return torch.einsum("bsf,fd->bsd", h, w2) + b2

    x = A_x
    xn = _layernorm(x, axis=-1)
    return x + _A_ref(xn, A_wqkv, A_wo) + _B_ref(xn, B_w1, B_b1, B_w2, B_b2)
```

```asm
; @launch grid=(256,1,1) block=(512,1,1) lds=163840
.amdgcn_target "amdgcn-amd-amdhsa--gfx950"
.text
.globl parallel_sum__softmax_full_mha__dense_activation_gelu__prompt_kernel
.p2align 8
.type parallel_sum__softmax_full_mha__dense_activation_gelu__prompt_kernel,@function
parallel_sum__softmax_full_mha__dense_activation_gelu__prompt_kernel:
    s_cmp_ge_u32 s2, 256
    s_cbranch_scc1 L_end
    s_load_dwordx16 s[36:51], s[0:1], 0
    s_load_dwordx4 s[52:55], s[0:1], 64
    s_load_dwordx2 s[56:57], s[0:1], 80
    v_lshrrev_b32 v2, 6, v0
    v_and_b32 v1, 63, v0
    v_readfirstlane_b32 s58, v2
    s_and_b32 s64, s2, 3
    s_lshl_b32 s64, s64, 2
    s_bfe_u32 s65, s2, 0x20003
    s_add_u32 s59, s64, s65
    s_lshr_b32 s65, s2, 5
    s_and_b32 s64, s2, 4
    s_lshl_b32 s64, s64, 1
    s_add_u32 s60, s64, s65
    s_mul_i32 s61, s60, 3
    s_lshl_b32 s64, s60, 1
    s_add_u32 s64, s64, 11
    s_min_u32 s61, s61, s64
    s_and_b32 s62, s58, 3
    s_cmp_lt_u32 s58, 4
    s_cbranch_scc1 L_p1c_1
    s_lshl_b32 s64, s59, 1
    s_add_u32 s76, s64, s65
    s_and_b32 s76, s76, 6
    v_lshrrev_b32 v16, 3, v1
    v_lshrrev_b32 v17, 4, v1
    v_and_b32 v18, 7, v1
    v_xor_b32 v18, v18, v17
    v_lshlrev_b32 v18, 4, v18
    v_lshl_add_u32 v20, v16, 10, v18
    v_xor_b32 v21, 64, v20
    v_add_u32 v21, 0x2000, v21
    s_lshl_b32 s72, s59, 17
    s_lshl_b32 s64, s62, 15
    s_add_u32 s72, s72, s64
    s_lshl_b32 s74, s62, 12
    s_mov_b32 s80, s76
    v_add_u32 v16, 0, v1
    v_mul_u32_u24 v17, 0x556, v16
    v_lshrrev_b32 v17, 14, v17
    v_mul_u32_u24 v18, 2880, v17
    v_lshl_add_u32 v22, v16, 4, v18
    v_mul_u32_u24 v18, 2560, v17
    v_lshl_add_u32 v25, v16, 4, v18
    v_add_u32 v16, 64, v1
    v_mul_u32_u24 v17, 0x556, v16
    v_lshrrev_b32 v17, 14, v17
    v_mul_u32_u24 v18, 2880, v17
    v_lshl_add_u32 v23, v16, 4, v18
    v_mul_u32_u24 v18, 2560, v17
    v_lshl_add_u32 v26, v16, 4, v18
    v_add_u32 v16, 128, v1
    v_mul_u32_u24 v17, 0x556, v16
    v_lshrrev_b32 v17, 14, v17
    v_mul_u32_u24 v18, 2880, v17
    v_lshl_add_u32 v24, v16, 4, v18
    v_mul_u32_u24 v18, 2560, v17
    v_lshl_add_u32 v27, v16, 4, v18
    s_mul_i32 s73, s60, 192
    s_mul_i32 s64, s62, 49152
    s_add_u32 s73, s73, s64
    s_mul_i32 s75, s62, 3072
    s_mov_b32 s10, 2097152
    s_mov_b32 s11, 0x20000
    s_mov_b32 s14, 1572864
    s_mov_b32 s15, 0x20000
    s_mov_b32 s79, 0
    s_mov_b32 s77, 0
    s_waitcnt lgkmcnt(0)
    s_mov_b32 s8, s36
    s_mov_b32 s9, s37
    s_mov_b32 s12, s38
    s_mov_b32 s13, s39
    s_lshl_b32 s64, s76, 7
    s_add_u32 s64, s64, s72
    s_add_u32 m0, s74, s79
    s_mul_i32 s65, s76, 196608
    buffer_load_dwordx4 v20, s[8:11], s64 offen lds
    s_add_u32 m0, m0, 1024
    s_add_u32 s65, s65, s73
    buffer_load_dwordx4 v21, s[8:11], s64 offen lds
    s_add_u32 m0, m0, 1024
    s_add_u32 s64, s64, 0x4000
    buffer_load_dwordx4 v20, s[8:11], s64 offen lds
    s_add_u32 m0, m0, 1024
    s_add_u32 s66, s75, s79
    buffer_load_dwordx4 v21, s[8:11], s64 offen lds
    s_add_u32 m0, s66, 16384
    s_add_u32 s76, s76, 1
    buffer_load_dwordx4 v22, s[12:15], s65 offen lds
    s_add_u32 m0, m0, 1024
    s_and_b32 s76, s76, 7
    buffer_load_dwordx4 v23, s[12:15], s65 offen lds
    s_add_u32 m0, m0, 1024
    s_nop 0
    buffer_load_dwordx4 v24, s[12:15], s65 offen lds
    s_mov_b32 s20, s46
    s_mov_b32 s21, s47
    s_mov_b32 s22, 0xac0
    s_mov_b32 s23, 0x20000
    s_min_u32 s66, s62, 2
    s_lshl_b32 s66, s66, 6
    s_lshl_b32 s64, s61, 6
    s_add_u32 s64, s64, s66
    v_and_b32 v16, 31, v1
    v_lshlrev_b32 v17, 1, v16
    buffer_load_ushort v29, v17, s[20:23], s64 offen
    s_lshl_b32 s64, s66, 3
    s_add_u32 s64, s64, 147456
    v_lshl_add_u32 v31, v16, 4, s64
    v_lshrrev_b32 v16, 5, v1
    v_bfe_u32 v17, v1, 2, 2
    v_lshl_add_u32 v16, v16, 2, v17
    v_mul_u32_u24 v16, 192, v16
    v_bfe_u32 v17, v1, 4, 1
    v_lshl_add_u32 v16, v17, 5, v16
    v_and_b32 v17, 3, v1
    v_lshl_add_u32 v16, v17, 3, v16
    s_add_u32 s66, s66, 16384
    v_add_u32 v28, s66, v16
    v_mov_b32 v32, 0
    v_and_b32 v16, 2, v1
    v_cmp_eq_u32 vcc, 0, v16
    v_mov_b32 v33, 0x3f803f80
    v_and_b32 v16, 1, v1
    v_cndmask_b32 v36, 0, v33, vcc
    v_cndmask_b32 v37, 0, v33, vcc
    v_cndmask_b32 v38, v33, 0, vcc
    v_cndmask_b32 v39, v33, 0, vcc
    v_mul_u32_u24 v33, 0xaaaa, v16
    v_add_u32 v33, 0x4444, v33
    v_mov_b32 v40, 0
    v_mov_b32 v41, 0
    v_mov_b32 v42, 0
    v_mov_b32 v43, 0
    s_mov_b32 s16, s56
    s_mov_b32 s17, s57
    s_mov_b32 s18, 0x1000000
    s_mov_b32 s19, 0x20000
    s_mov_b32 s32, s54
    s_mov_b32 s33, s55
    s_mov_b32 s34, 0x100
    s_mov_b32 s35, 0x20000
    s_mov_b32 s24, s44
    s_mov_b32 s25, s45
    s_mov_b32 s26, 0x158000
    s_mov_b32 s27, 0x20000
    s_mov_b32 s79, 28672
    v_mov_b32 v19, 150528
    ds_write_b32 v19, v32
    ds_write_b32 v19, v32 offset:4
    s_setprio 2
    s_lshl_b32 s64, s76, 7
    s_add_u32 s64, s64, s72
    s_add_u32 m0, s74, s79
    s_mul_i32 s65, s76, 196608
    buffer_load_dwordx4 v20, s[8:11], s64 offen lds
    s_add_u32 m0, m0, 1024
    s_add_u32 s65, s65, s73
    buffer_load_dwordx4 v21, s[8:11], s64 offen lds
    s_add_u32 m0, m0, 1024
    s_add_u32 s64, s64, 0x4000
    buffer_load_dwordx4 v20, s[8:11], s64 offen lds
    s_add_u32 m0, m0, 1024
    s_add_u32 s66, s75, s79
    buffer_load_dwordx4 v21, s[8:11], s64 offen lds
    s_add_u32 m0, s66, 16384
    s_add_u32 s76, s76, 1
    buffer_load_dwordx4 v22, s[12:15], s65 offen lds
    s_add_u32 m0, m0, 1024
    s_and_b32 s76, s76, 7
    buffer_load_dwordx4 v23, s[12:15], s65 offen lds
    s_add_u32 m0, m0, 1024
    s_nop 0
    buffer_load_dwordx4 v24, s[12:15], s65 offen lds
    s_mov_b32 s79, 57344
    s_waitcnt vmcnt(8)
    s_branch L_hw_3_b
.p2align 3
L_hloop_2:
    s_cmp_lt_u32 s77, 7
    s_cbranch_scc1 L_hw_3
    s_waitcnt vmcnt(10)
    s_branch L_hw_3_b
L_hw_3:
    s_waitcnt vmcnt(7)
L_hw_3_b:
    s_barrier
    s_cmp_lt_u32 s77, 6
    s_cbranch_scc0 L_hnd_4
L_hnd_4_go:
    s_lshl_b32 s64, s76, 7
    s_add_u32 s64, s64, s72
    s_add_u32 m0, s74, s79
    s_mul_i32 s65, s76, 196608
    buffer_load_dwordx4 v20, s[8:11], s64 offen lds
    ds_read_b64_tr_b16 v[44:45], v28 offset:0
    ds_read_b64_tr_b16 v[46:47], v28 offset:1536
    s_add_u32 m0, m0, 1024
    s_add_u32 s65, s65, s73
    buffer_load_dwordx4 v21, s[8:11], s64 offen lds
    ds_read_b64_tr_b16 v[48:49], v28 offset:3072
    ds_read_b64_tr_b16 v[50:51], v28 offset:4608
    s_add_u32 m0, m0, 1024
    s_add_u32 s64, s64, 0x4000
    buffer_load_dwordx4 v20, s[8:11], s64 offen lds
    ds_read_b64_tr_b16 v[52:53], v28 offset:6144
    ds_read_b64_tr_b16 v[54:55], v28 offset:7680
    s_add_u32 m0, m0, 1024
    s_add_u32 s66, s75, s79
    buffer_load_dwordx4 v21, s[8:11], s64 offen lds
    ds_read_b64_tr_b16 v[56:57], v28 offset:9216
    ds_read_b64_tr_b16 v[58:59], v28 offset:10752
    s_add_u32 m0, s66, 16384
    s_add_u32 s76, s76, 1
    buffer_load_dwordx4 v22, s[12:15], s65 offen lds
    s_add_u32 m0, m0, 1024
    s_and_b32 s76, s76, 7
    buffer_load_dwordx4 v23, s[12:15], s65 offen lds
    s_add_u32 m0, m0, 1024
    s_nop 0
    buffer_load_dwordx4 v24, s[12:15], s65 offen lds
    s_branch L_hnx_5
L_hnd_4:
    ds_read_b64_tr_b16 v[44:45], v28 offset:0
    ds_read_b64_tr_b16 v[46:47], v28 offset:1536
    ds_read_b64_tr_b16 v[48:49], v28 offset:3072
    ds_read_b64_tr_b16 v[50:51], v28 offset:4608
    ds_read_b64_tr_b16 v[52:53], v28 offset:6144
    ds_read_b64_tr_b16 v[54:55], v28 offset:7680
    ds_read_b64_tr_b16 v[56:57], v28 offset:9216
    ds_read_b64_tr_b16 v[58:59], v28 offset:10752
    s_cmp_eq_u32 s77, 6
    s_cbranch_scc0 L_hnd_4_7
    buffer_load_dword v30, v32, s[32:35], 0 offen sc1
    s_lshl_b32 s73, s61, 6
    s_mul_i32 s64, s62, 44032
    s_add_u32 s73, s73, s64
    s_add_u32 s64, s80, 0
    s_and_b32 s64, s64, 7
    s_mul_i32 s64, s64, 176128
    s_add_u32 m0, s75, 86016
    s_add_u32 s64, s64, s73
    buffer_load_dwordx4 v25, s[24:27], s64 offen lds
    s_add_u32 m0, m0, 1024
    s_nop 0
    buffer_load_dwordx4 v26, s[24:27], s64 offen lds
    s_add_u32 m0, m0, 1024
    s_nop 0
    buffer_load_dwordx4 v27, s[24:27], s64 offen lds
    s_add_u32 s64, s80, 1
    s_and_b32 s64, s64, 7
    s_mul_i32 s64, s64, 176128
    s_add_u32 m0, s75, 98304
    s_add_u32 s64, s64, s73
    buffer_load_dwordx4 v25, s[24:27], s64 offen lds
    s_add_u32 m0, m0, 1024
    s_nop 0
    buffer_load_dwordx4 v26, s[24:27], s64 offen lds
    s_add_u32 m0, m0, 1024
    s_nop 0
    buffer_load_dwordx4 v27, s[24:27], s64 offen lds
    s_add_u32 s64, s80, 2
    s_and_b32 s64, s64, 7
    s_mul_i32 s64, s64, 176128
    s_add_u32 m0, s75, 110592
    s_add_u32 s64, s64, s73
    buffer_load_dwordx4 v25, s[24:27], s64 offen lds
    s_add_u32 m0, m0, 1024
    s_nop 0
    buffer_load_dwordx4 v26, s[24:27], s64 offen lds
    s_add_u32 m0, m0, 1024
    s_nop 0
    buffer_load_dwordx4 v27, s[24:27], s64 offen lds
    s_branch L_hnx_5
L_hnd_4_7:
L_hnx_5:
    s_add_u32 s77, s77, 1
    s_add_u32 s79, s79, 28672
    s_cmp_eq_u32 s79, 86016
    s_cselect_b32 s79, 0, s79
    s_mov_b32 s78, 28672
    s_cmp_eq_u32 s79, 57344
    s_cmov_b32 s78, 0xffff2000
    s_waitcnt lgkmcnt(0)
    v_smfmac_f32_16x16x64_bf16 v[40:43], v[36:39], v[44:51], v33
    v_smfmac_f32_16x16x64_bf16 v[40:43], v[36:39], v[52:59], v33
    v_add_u32 v28, s78, v28
    s_cmp_lt_u32 s77, 8
    s_cbranch_scc1 L_hloop_2
    v_and_b32 v17, 16, v1
    v_cmp_eq_u32 vcc, 0, v17
    v_mov_b32 v78, 0
    v_mov_b32 v79, 0
    s_nop 3
    v_add_f32 v40, v40, v41
    v_add_f32 v42, v42, v43
    v_cndmask_b32 v40, v42, v40, vcc
    v_cvt_pk_bf16_f32 v76, v40, v40
    v_and_b32 v17, 0xffff0000, v76
    v_sub_f32 v17, v40, v17
    v_cvt_pk_bf16_f32 v17, v17, 0
    v_lshl_or_b32 v77, v78, 16, v17
    ds_write_b128 v31, v[76:79] offset:0
    s_waitcnt vmcnt(3)
L_rdy_6:
    v_readfirstlane_b32 s64, v30
    s_cmp_lg_u32 s64, 0
    s_cbranch_scc1 L_rdy_6_ok
    s_sleep 1
    buffer_load_dword v30, v32, s[32:35], 0 offen sc1
    s_waitcnt vmcnt(0)
    s_branch L_rdy_6
L_rdy_6_ok:
    s_waitcnt lgkmcnt(0)
    s_barrier
    v_add_u32 v28, 0x3000, v28
    v_mov_b32 v40, 0
    v_mov_b32 v41, 0
    v_mov_b32 v42, 0
    v_mov_b32 v43, 0
    s_cmp_eq_u32 s58, 7
    s_cbranch_scc1 L_cs_7
    ds_read_b64_tr_b16 v[44:45], v28 offset:0
    ds_read_b64_tr_b16 v[46:47], v28 offset:1536
    ds_read_b64_tr_b16 v[48:49], v28 offset:3072
    ds_read_b64_tr_b16 v[50:51], v28 offset:4608
    ds_read_b64_tr_b16 v[52:53], v28 offset:6144
    ds_read_b64_tr_b16 v[54:55], v28 offset:7680
    ds_read_b64_tr_b16 v[56:57], v28 offset:9216
    ds_read_b64_tr_b16 v[58:59], v28 offset:10752
    ds_read_b64_tr_b16 v[60:61], v28 offset:12288
    ds_read_b64_tr_b16 v[62:63], v28 offset:13824
    ds_read_b64_tr_b16 v[64:65], v28 offset:15360
    ds_read_b64_tr_b16 v[66:67], v28 offset:16896
    ds_read_b64_tr_b16 v[68:69], v28 offset:18432
    ds_read_b64_tr_b16 v[70:71], v28 offset:19968
    ds_read_b64_tr_b16 v[72:73], v28 offset:21504
    s_waitcnt lgkmcnt(7)
    v_smfmac_f32_16x16x64_bf16 v[40:43], v[36:39], v[44:51], v33
    v_smfmac_f32_16x16x64_bf16 v[40:43], v[36:39], v[52:59], v33
    ds_read_b64_tr_b16 v[74:75], v28 offset:23040
    s_waitcnt lgkmcnt(0)
    v_smfmac_f32_16x16x64_bf16 v[40:43], v[36:39], v[60:67], v33
    v_smfmac_f32_16x16x64_bf16 v[40:43], v[36:39], v[68:75], v33
L_cs_7:
    s_add_u32 s64, s80, 3
    s_and_b32 s64, s64, 7
    s_mul_i32 s64, s64, 176128
    s_add_u32 m0, s75, 122880
    s_add_u32 s64, s64, s73
    buffer_load_dwordx4 v25, s[24:27], s64 offen lds
    s_add_u32 m0, m0, 1024
    s_nop 0
    buffer_load_dwordx4 v26, s[24:27], s64 offen lds
    s_add_u32 m0, m0, 1024
    s_nop 0
    buffer_load_dwordx4 v27, s[24:27], s64 offen lds
    s_add_u32 s64, s80, 4
    s_and_b32 s64, s64, 7
    s_mul_i32 s64, s64, 176128
    s_add_u32 m0, s75, 135168
    s_add_u32 s64, s64, s73
    buffer_load_dwordx4 v25, s[24:27], s64 offen lds
    s_add_u32 m0, m0, 1024
    s_nop 0
    buffer_load_dwordx4 v26, s[24:27], s64 offen lds
    s_add_u32 m0, m0, 1024
    s_nop 0
    buffer_load_dwordx4 v27, s[24:27], s64 offen lds
    s_waitcnt vmcnt(6)
    s_barrier
    s_add_u32 s64, s80, 5
    s_and_b32 s64, s64, 7
    s_mul_i32 s64, s64, 176128
    s_add_u32 m0, s75, 20480
    s_add_u32 s64, s64, s73
    buffer_load_dwordx4 v25, s[24:27], s64 offen lds
    s_add_u32 m0, m0, 1024
    s_nop 0
    buffer_load_dwordx4 v26, s[24:27], s64 offen lds
    s_add_u32 m0, m0, 1024
    s_nop 0
    buffer_load_dwordx4 v27, s[24:27], s64 offen lds
    s_add_u32 s64, s80, 6
    s_and_b32 s64, s64, 7
    s_mul_i32 s64, s64, 176128
    s_add_u32 m0, s75, 32768
    s_add_u32 s64, s64, s73
    buffer_load_dwordx4 v25, s[24:27], s64 offen lds
    s_add_u32 m0, m0, 1024
    s_nop 0
    buffer_load_dwordx4 v26, s[24:27], s64 offen lds
    s_add_u32 m0, m0, 1024
    s_nop 0
    buffer_load_dwordx4 v27, s[24:27], s64 offen lds
    s_add_u32 s64, s80, 7
    s_and_b32 s64, s64, 7
    s_mul_i32 s64, s64, 176128
    s_add_u32 m0, s75, 45056
    s_add_u32 s64, s64, s73
    buffer_load_dwordx4 v25, s[24:27], s64 offen lds
    s_add_u32 m0, m0, 1024
    s_nop 0
    buffer_load_dwordx4 v26, s[24:27], s64 offen lds
    s_add_u32 m0, m0, 1024
    s_nop 0
    buffer_load_dwordx4 v27, s[24:27], s64 offen lds
    s_cmp_eq_u32 s58, 7
    s_cbranch_scc1 L_cs_8
    ds_read_b64_tr_b16 v[44:45], v28 offset:24576
    ds_read_b64_tr_b16 v[46:47], v28 offset:26112
    ds_read_b64_tr_b16 v[48:49], v28 offset:27648
    ds_read_b64_tr_b16 v[50:51], v28 offset:29184
    ds_read_b64_tr_b16 v[52:53], v28 offset:30720
    ds_read_b64_tr_b16 v[54:55], v28 offset:32256
    ds_read_b64_tr_b16 v[56:57], v28 offset:33792
    ds_read_b64_tr_b16 v[58:59], v28 offset:35328
    s_waitcnt lgkmcnt(0)
    v_smfmac_f32_16x16x64_bf16 v[40:43], v[36:39], v[44:51], v33
    v_smfmac_f32_16x16x64_bf16 v[40:43], v[36:39], v[52:59], v33
L_cs_8:
    s_waitcnt vmcnt(9)
    s_barrier
    s_cmp_eq_u32 s58, 7
    s_cbranch_scc1 L_cs_9
    ds_read_b64_tr_b16 v[44:45], v28 offset:36864
    ds_read_b64_tr_b16 v[46:47], v28 offset:38400
    ds_read_b64_tr_b16 v[48:49], v28 offset:39936
    ds_read_b64_tr_b16 v[50:51], v28 offset:41472
    ds_read_b64_tr_b16 v[52:53], v28 offset:43008
    ds_read_b64_tr_b16 v[54:55], v28 offset:44544
    ds_read_b64_tr_b16 v[56:57], v28 offset:46080
    ds_read_b64_tr_b16 v[58:59], v28 offset:47616
    ds_read_b64_tr_b16 v[60:61], v28 offset:49152
    ds_read_b64_tr_b16 v[62:63], v28 offset:50688
    ds_read_b64_tr_b16 v[64:65], v28 offset:52224
    ds_read_b64_tr_b16 v[66:67], v28 offset:53760
    ds_read_b64_tr_b16 v[68:69], v28 offset:55296
    ds_read_b64_tr_b16 v[70:71], v28 offset:56832
    ds_read_b64_tr_b16 v[72:73], v28 offset:58368
    s_waitcnt lgkmcnt(7)
    v_smfmac_f32_16x16x64_bf16 v[40:43], v[36:39], v[44:51], v33
    v_smfmac_f32_16x16x64_bf16 v[40:43], v[36:39], v[52:59], v33
    ds_read_b64_tr_b16 v[74:75], v28 offset:59904
    s_waitcnt lgkmcnt(0)
    v_smfmac_f32_16x16x64_bf16 v[40:43], v[36:39], v[60:67], v33
    v_smfmac_f32_16x16x64_bf16 v[40:43], v[36:39], v[68:75], v33
L_cs_9:
    v_add_u32 v28, 0xffff0000, v28
    s_and_b32 s64, s2, 7
    s_lshl_b32 s64, s64, 2
    s_bfe_u32 s65, s2, 0x20003
    s_add_u32 s59, s64, s65
    s_lshr_b32 s60, s2, 5
    s_and_b32 s61, s58, 3
    s_lshr_b32 s62, s58, 2
    v_lshlrev_b32 v6, 4, v1
    v_lshlrev_b32 v8, 2, v1
    v_and_b32 v9, 28, v8
    s_lshr_b32 s64, s59, 1
    s_add_u32 s64, s64, 16
    s_mul_i32 s64, s64, 86
    s_and_b32 s64, s64, 0xff00
    s_add_u32 s81, s64, 7340032
    s_lshr_b32 s64, s59, 1
    s_add_u32 s64, s64, 32
    s_mul_i32 s64, s64, 86
    s_and_b32 s64, s64, 0xff00
    s_add_u32 s82, s64, 7340032
    s_lshr_b32 s64, s59, 1
    s_add_u32 s64, s64, 0
    s_mul_i32 s64, s64, 86
    s_and_b32 s64, s64, 0xff00
    s_add_u32 s83, s64, 7340032
    s_lshl_b32 s64, s60, 5
    s_add_u32 s83, s83, s64
    s_waitcnt vmcnt(0)
    s_barrier
    s_cmp_eq_u32 s58, 7
    s_cbranch_scc1 L_h7_10
    s_cmp_eq_u32 s58, 7
    s_cbranch_scc1 L_cs_11
    ds_read_b64_tr_b16 v[44:45], v28 offset:0
    ds_read_b64_tr_b16 v[46:47], v28 offset:1536
    ds_read_b64_tr_b16 v[48:49], v28 offset:3072
    ds_read_b64_tr_b16 v[50:51], v28 offset:4608
    ds_read_b64_tr_b16 v[52:53], v28 offset:6144
    ds_read_b64_tr_b16 v[54:55], v28 offset:7680
    ds_read_b64_tr_b16 v[56:57], v28 offset:9216
    ds_read_b64_tr_b16 v[58:59], v28 offset:10752
    ds_read_b64_tr_b16 v[60:61], v28 offset:12288
    ds_read_b64_tr_b16 v[62:63], v28 offset:13824
    ds_read_b64_tr_b16 v[64:65], v28 offset:15360
    ds_read_b64_tr_b16 v[66:67], v28 offset:16896
    ds_read_b64_tr_b16 v[68:69], v28 offset:18432
    ds_read_b64_tr_b16 v[70:71], v28 offset:19968
    ds_read_b64_tr_b16 v[72:73], v28 offset:21504
    s_waitcnt lgkmcnt(7)
    v_smfmac_f32_16x16x64_bf16 v[40:43], v[36:39], v[44:51], v33
    v_smfmac_f32_16x16x64_bf16 v[40:43], v[36:39], v[52:59], v33
    ds_read_b64_tr_b16 v[74:75], v28 offset:23040
    ds_read_b64_tr_b16 v[44:45], v28 offset:24576
    ds_read_b64_tr_b16 v[46:47], v28 offset:26112
    ds_read_b64_tr_b16 v[48:49], v28 offset:27648
    ds_read_b64_tr_b16 v[50:51], v28 offset:29184
    ds_read_b64_tr_b16 v[52:53], v28 offset:30720
    ds_read_b64_tr_b16 v[54:55], v28 offset:32256
    ds_read_b64_tr_b16 v[56:57], v28 offset:33792
    s_waitcnt lgkmcnt(7)
    v_smfmac_f32_16x16x64_bf16 v[40:43], v[36:39], v[60:67], v33
    v_smfmac_f32_16x16x64_bf16 v[40:43], v[36:39], v[68:75], v33
    ds_read_b64_tr_b16 v[58:59], v28 offset:35328
    s_waitcnt lgkmcnt(0)
    v_smfmac_f32_16x16x64_bf16 v[40:43], v[36:39], v[44:51], v33
    v_smfmac_f32_16x16x64_bf16 v[40:43], v[36:39], v[52:59], v33
L_cs_11:
    v_and_b32 v17, 16, v1
    v_cmp_eq_u32 vcc, 0, v17
    v_mov_b32 v78, v29
    v_mov_b32 v79, 0
    s_nop 3
    v_add_f32 v40, v40, v41
    v_add_f32 v42, v42, v43
    v_cndmask_b32 v40, v42, v40, vcc
    v_cvt_pk_bf16_f32 v76, v40, v40
    v_and_b32 v17, 0xffff0000, v76
    v_sub_f32 v17, v40, v17
    v_cvt_pk_bf16_f32 v17, v17, 0
    v_lshl_or_b32 v77, v78, 16, v17
    ds_write_b128 v31, v[76:79] offset:1536
    v_mov_b32 v16, 1
    s_waitcnt lgkmcnt(0)
    s_mov_b64 exec, 1
    ds_add_u32 v19, v16
    s_mov_b64 exec, -1
L_h7_10:
    s_branch L_p2h
L_p1c_1:
    s_getpc_b64 s[64:65]
    s_and_b32 s64, s64, 0xffffff00
    v_lshlrev_b32 v2, 7, v0
    global_load_dword v15, v2, s[64:65]
    v_lshlrev_b32 v11, 4, v1
    s_waitcnt lgkmcnt(0)
    s_mov_b32 s16, s56
    s_mov_b32 s17, s57
    s_mov_b32 s18, 0x1000000
    s_mov_b32 s19, 0x20000
    s_or_b32 s64, s2, s58
    s_cmp_eq_u32 s64, 0
    s_cbranch_scc0 L_nclr_12
    s_mov_b32 s32, s54
    s_mov_b32 s33, s55
    s_mov_b32 s34, 0x100
    s_mov_b32 s35, 0x20000
    v_mov_b32 v48, 0
    v_mov_b32 v49, 0
    v_mov_b32 v50, 0
    v_mov_b32 v51, 0
    s_mov_b32 s64, 7340032
    buffer_store_dwordx4 v[48:51], v11, s[16:19], s64 offen offset:0 sc1
    buffer_store_dwordx4 v[48:51], v11, s[16:19], s64 offen offset:1024 sc1
    buffer_store_dwordx4 v[48:51], v11, s[16:19], s64 offen offset:2048 sc1
    buffer_store_dwordx4 v[48:51], v11, s[16:19], s64 offen offset:3072 sc1
    s_add_u32 s64, s64, 4096
    buffer_store_dwordx4 v[48:51], v11, s[16:19], s64 offen offset:0 sc1
    buffer_store_dwordx4 v[48:51], v11, s[16:19], s64 offen offset:1024 sc1
    buffer_store_dwordx4 v[48:51], v11, s[16:19], s64 offen offset:2048 sc1
    buffer_store_dwordx4 v[48:51], v11, s[16:19], s64 offen offset:3072 sc1
    s_add_u32 s64, s64, 4096
    buffer_store_dwordx4 v[48:51], v11, s[16:19], s64 offen offset:0 sc1
    buffer_store_dwordx4 v[48:51], v11, s[16:19], s64 offen offset:1024 sc1
    buffer_store_dwordx4 v[48:51], v11, s[16:19], s64 offen offset:2048 sc1
    buffer_store_dwordx4 v[48:51], v11, s[16:19], s64 offen offset:3072 sc1
    s_add_u32 s64, s64, 4096
    buffer_store_dwordx4 v[48:51], v11, s[16:19], s64 offen offset:0 sc1
    buffer_store_dwordx4 v[48:51], v11, s[16:19], s64 offen offset:1024 sc1
    buffer_store_dwordx4 v[48:51], v11, s[16:19], s64 offen offset:2048 sc1
    buffer_store_dwordx4 v[48:51], v11, s[16:19], s64 offen offset:3072 sc1
    v_mov_b32 v2, 1
    s_waitcnt vmcnt(0)
    s_mov_b64 exec, 1
    buffer_store_dword v2, v48, s[32:35], 0 offen sc1
    s_mov_b64 exec, -1
L_nclr_12:
    v_and_b32 v2, 31, v1
    v_lshrrev_b32 v3, 5, v1
    v_bfe_u32 v4, v1, 1, 3
    v_xor_b32 v4, v4, v3
    v_lshlrev_b32 v4, 4, v4
    v_lshl_add_u32 v4, v2, 7, v4
    s_lshl_b32 s64, s58, 12
    v_add_u32 v6, s64, v4
    v_xor_b32 v7, 32, v6
    v_xor_b32 v8, 64, v6
    v_xor_b32 v9, 96, v6
    v_lshlrev_b32 v14, 4, v2
    v_add_u32 v14, 147456, v14
    v_lshlrev_b32 v2, 5, v2
    v_lshl_add_u32 v2, v3, 3, v2
    s_mul_i32 s64, s58, 6144
    s_add_u32 s64, s64, 57344
    v_add_u32 v12, s64, v2
    v_lshrrev_b32 v2, 4, v1
    v_bfe_u32 v4, v1, 2, 2
    v_lshl_add_u32 v2, v2, 3, v4
    v_and_b32 v5, 3, v1
    v_lshlrev_b32 v5, 3, v5
    v_lshl_add_u32 v2, v2, 5, v5
    v_add_u32 v13, s64, v2
    v_lshl_add_u32 v2, v3, 3, v4
    v_mul_u32_u24 v2, 192, v2
    v_bfe_u32 v3, v1, 4, 1
    v_lshlrev_b32 v3, 5, v3
    v_add3_u32 v10, v2, v3, v5
    v_and_b32 v2, 2, v1
    v_cmp_eq_u32 vcc, 0, v2
    v_mov_b32 v17, 0x3f803f80
    v_and_b32 v2, 1, v1
    v_cndmask_b32 v24, 0, v17, vcc
    v_cndmask_b32 v25, 0, v17, vcc
    v_cndmask_b32 v26, v17, 0, vcc
    v_cndmask_b32 v27, v17, 0, vcc
    v_mul_u32_u24 v17, 0xaaaa, v2
    v_add_u32 v17, 0x4444, v17
    v_mov_b32 v28, 0
    v_mov_b32 v32, 0
    v_mov_b32 v36, 0
    v_mov_b32 v40, 0
    v_mov_b32 v29, 0
    v_mov_b32 v33, 0
    v_mov_b32 v37, 0
    v_mov_b32 v41, 0
    v_mov_b32 v30, 0
    v_mov_b32 v34, 0
    v_mov_b32 v38, 0
    v_mov_b32 v42, 0
    v_mov_b32 v31, 0
    v_mov_b32 v35, 0
    v_mov_b32 v39, 0
    v_mov_b32 v43, 0
    s_mov_b32 s24, s44
    s_mov_b32 s25, s45
    s_mov_b32 s26, 0x158000
    s_mov_b32 s27, 0x20000
    s_and_b32 s64, s59, 3
    s_lshl_b32 s64, s64, 2
    s_add_u32 s64, s64, s58
    s_mul_i32 s64, s64, 88064
    s_lshl_b32 s65, s61, 6
    s_add_u32 s64, s64, s65
    v_lshrrev_b32 v2, 1, v1
    v_mul_u32_u24 v2, 2752, v2
    v_and_b32 v3, 1, v1
    v_mul_u32_u24 v3, 188, v3
    v_add3_u32 v16, v2, v3, s64
    s_lshl_b32 s70, s59, 2
    s_add_u32 s70, s70, s58
    s_mul_i32 s71, s60, 3
    s_add_u32 s66, s71, 0
    s_and_b32 s67, s66, 15
    s_lshl_b32 s67, s67, 7
    s_add_u32 s67, s67, s70
    s_cmp_lt_u32 s66, 16
    s_cselect_b32 s68, 10, 11
    s_cselect_b32 s69, 0, 2097152
    s_lshl_b32 s67, s67, s68
    s_add_u32 s67, s67, s69
    s_lshl_b32 s68, 64, s68
    s_cmp_ge_u32 s66, 32
    s_cselect_b32 s69, 1024, 0
    s_add_u32 s72, s67, s69
    s_add_u32 s73, s72, s68
    s_add_u32 s66, s71, 1
    s_and_b32 s67, s66, 15
    s_lshl_b32 s67, s67, 7
    s_add_u32 s67, s67, s70
    s_cmp_lt_u32 s66, 16
    s_cselect_b32 s68, 10, 11
    s_cselect_b32 s69, 0, 2097152
    s_lshl_b32 s67, s67, s68
    s_add_u32 s67, s67, s69
    s_lshl_b32 s68, 64, s68
    s_cmp_ge_u32 s66, 32
    s_cselect_b32 s69, 1024, 0
    s_add_u32 s74, s67, s69
    s_add_u32 s75, s74, s68
    s_add_u32 s66, s71, 2
    s_and_b32 s67, s66, 15
    s_lshl_b32 s67, s67, 7
    s_add_u32 s67, s67, s70
    s_cmp_lt_u32 s66, 16
    s_cselect_b32 s68, 10, 11
    s_cselect_b32 s69, 0, 2097152
    s_lshl_b32 s67, s67, s68
    s_add_u32 s67, s67, s69
    s_lshl_b32 s68, 64, s68
    s_cmp_ge_u32 s66, 32
    s_cselect_b32 s69, 1024, 0
    s_add_u32 s76, s67, s69
    s_add_u32 s77, s76, s68
    s_lshl_b32 s78, s60, 6
    s_add_u32 s78, s78, s70
    s_lshl_b32 s78, s78, 2
    s_add_u32 s78, s78, 7340032
    s_lshl_b32 s80, s70, 4
    s_add_u32 s80, s80, s60
    s_lshl_b32 s80, s80, 2
    s_add_u32 s80, s80, 7344128
    s_mul_i32 s79, s70, 118
    s_lshl_b32 s64, s61, 1
    s_add_u32 s79, s79, s64
    s_add_u32 s79, s79, 32
    s_lshl_b32 s79, s79, 10
    s_add_u32 s79, s79, 8388608
    s_waitcnt lgkmcnt(0)
    s_barrier
    ds_read_b128 v[128:131], v6 offset:0
    ds_read_b64_tr_b16 v[44:45], v10 offset:16384
    ds_read_b64_tr_b16 v[46:47], v10 offset:17152
    ds_read_b64_tr_b16 v[48:49], v10 offset:16448
    ds_read_b64_tr_b16 v[50:51], v10 offset:17216
    ds_read_b64_tr_b16 v[52:53], v10 offset:16512
    ds_read_b64_tr_b16 v[54:55], v10 offset:17280
    ds_read_b128 v[132:135], v7 offset:0
    ds_read_b64_tr_b16 v[56:57], v10 offset:19456
    ds_read_b64_tr_b16 v[58:59], v10 offset:20224
    ds_read_b64_tr_b16 v[60:61], v10 offset:19520
    ds_read_b64_tr_b16 v[62:63], v10 offset:20288
    ds_read_b64_tr_b16 v[64:65], v10 offset:19584
    ds_read_b64_tr_b16 v[66:67], v10 offset:20352
    s_waitcnt lgkmcnt(7)
    v_mfma_f32_32x32x16_bf16 v[80:95], v[44:47], v[128:131], 0
    ds_read_b128 v[136:139], v8 offset:0
    ds_read_b64_tr_b16 v[68:69], v10 offset:22528
    v_mfma_f32_32x32x16_bf16 v[96:111], v[48:51], v[128:131], 0
    ds_read_b64_tr_b16 v[70:71], v10 offset:23296
    ds_read_b64_tr_b16 v[72:73], v10 offset:22592
    v_mfma_f32_32x32x16_bf16 v[112:127], v[52:55], v[128:131], 0
    ds_read_b64_tr_b16 v[74:75], v10 offset:23360
    ds_read_b64_tr_b16 v[76:77], v10 offset:22656
    ds_read_b64_tr_b16 v[78:79], v10 offset:23424
    s_waitcnt lgkmcnt(7)
    v_mfma_f32_32x32x16_bf16 v[80:95], v[56:59], v[132:135], v[80:95]
    ds_read_b128 v[140:143], v9 offset:0
    ds_read_b64_tr_b16 v[44:45], v10 offset:25600
    v_mfma_f32_32x32x16_bf16 v[96:111], v[60:63], v[132:135], v[96:111]
    ds_read_b64_tr_b16 v[46:47], v10 offset:26368
    ds_read_b64_tr_b16 v[48:49], v10 offset:25664
    v_mfma_f32_32x32x16_bf16 v[112:127], v[64:67], v[132:135], v[112:127]
    ds_read_b64_tr_b16 v[50:51], v10 offset:26432
    ds_read_b64_tr_b16 v[52:53], v10 offset:25728
    ds_read_b64_tr_b16 v[54:55], v10 offset:26496
    v_smfmac_f32_16x16x64_bf16 v[28:31], v[24:27], v[128:135], v17
    v_mfma_f32_4x4x4_16b_bf16 v[32:35], v[128:129], v[128:129], v[32:35]
    v_mfma_f32_4x4x4_16b_bf16 v[40:43], v[130:131], v[130:131], v[40:43]
    v_mfma_f32_4x4x4_16b_bf16 v[36:39], v[132:133], v[132:133], v[36:39]
    v_mfma_f32_4x4x4_16b_bf16 v[32:35], v[134:135], v[134:135], v[32:35]
    s_waitcnt lgkmcnt(0)
    s_barrier
    s_waitcnt lgkmcnt(7)
    v_mfma_f32_32x32x16_bf16 v[80:95], v[68:71], v[136:139], v[80:95]
    ds_read_b128 v[144:147], v6 offset:28672
    ds_read_b64_tr_b16 v[56:57], v10 offset:45056
    v_mfma_f32_32x32x16_bf16 v[96:111], v[72:75], v[136:139], v[96:111]
    ds_read_b64_tr_b16 v[58:59], v10 offset:45824
    ds_read_b64_tr_b16 v[60:61], v10 offset:45120
    v_mfma_f32_32x32x16_bf16 v[112:127], v[76:79], v[136:139], v[112:127]
    ds_read_b64_tr_b16 v[62:63], v10 offset:45888
    ds_read_b64_tr_b16 v[64:65], v10 offset:45184
    ds_read_b64_tr_b16 v[66:67], v10 offset:45952
    s_waitcnt lgkmcnt(7)
    v_mfma_f32_32x32x16_bf16 v[80:95], v[44:47], v[140:143], v[80:95]
    ds_read_b128 v[148:151], v7 offset:28672
    ds_read_b64_tr_b16 v[68:69], v10 offset:48128
    v_mfma_f32_32x32x16_bf16 v[96:111], v[48:51], v[140:143], v[96:111]
    ds_read_b64_tr_b16 v[70:71], v10 offset:48896
    ds_read_b64_tr_b16 v[72:73], v10 offset:48192
    v_mfma_f32_32x32x16_bf16 v[112:127], v[52:55], v[140:143], v[112:127]
    ds_read_b64_tr_b16 v[74:75], v10 offset:48960
    ds_read_b64_tr_b16 v[76:77], v10 offset:48256
    ds_read_b64_tr_b16 v[78:79], v10 offset:49024
    s_waitcnt lgkmcnt(7)
    v_mfma_f32_32x32x16_bf16 v[80:95], v[56:59], v[144:147], v[80:95]
    ds_read_b128 v[152:155], v8 offset:28672
    ds_read_b64_tr_b16 v[44:45], v10 offset:51200
    v_mfma_f32_32x32x16_bf16 v[96:111], v[60:63], v[144:147], v[96:111]
    ds_read_b64_tr_b16 v[46:47], v10 offset:51968
    ds_read_b64_tr_b16 v[48:49], v10 offset:51264
    v_mfma_f32_32x32x16_bf16 v[112:127], v[64:67], v[144:147], v[112:127]
    ds_read_b64_tr_b16 v[50:51], v10 offset:52032
    ds_read_b64_tr_b16 v[52:53], v10 offset:51328
    ds_read_b64_tr_b16 v[54:55], v10 offset:52096
    s_waitcnt lgkmcnt(7)
    v_mfma_f32_32x32x16_bf16 v[80:95], v[68:71], v[148:151], v[80:95]
    ds_read_b128 v[156:159], v9 offset:28672
    ds_read_b64_tr_b16 v[56:57], v10 offset:54272
    v_mfma_f32_32x32x16_bf16 v[96:111], v[72:75], v[148:151], v[96:111]
    ds_read_b64_tr_b16 v[58:59], v10 offset:55040
    ds_read_b64_tr_b16 v[60:61], v10 offset:54336
    v_mfma_f32_32x32x16_bf16 v[112:127], v[76:79], v[148:151], v[112:127]
    ds_read_b64_tr_b16 v[62:63], v10 offset:55104
    ds_read_b64_tr_b16 v[64:65], v10 offset:54400
    ds_read_b64_tr_b16 v[66:67], v10 offset:55168
    v_smfmac_f32_16x16x64_bf16 v[28:31], v[24:27], v[136:143], v17
    v_smfmac_f32_16x16x64_bf16 v[28:31], v[24:27], v[144:151], v17
    v_mfma_f32_4x4x4_16b_bf16 v[32:35], v[136:137], v[136:137], v[32:35]
    v_mfma_f32_4x4x4_16b_bf16 v[40:43], v[138:139], v[138:139], v[40:43]
    v_mfma_f32_4x4x4_16b_bf16 v[36:39], v[140:141], v[140:141], v[36:39]
    v_mfma_f32_4x4x4_16b_bf16 v[32:35], v[142:143], v[142:143], v[32:35]
    v_mfma_f32_4x4x4_16b_bf16 v[40:43], v[144:145], v[144:145], v[40:43]
    v_mfma_f32_4x4x4_16b_bf16 v[36:39], v[146:147], v[146:147], v[36:39]
    v_mfma_f32_4x4x4_16b_bf16 v[32:35], v[148:149], v[148:149], v[32:35]
    v_mfma_f32_4x4x4_16b_bf16 v[40:43], v[150:151], v[150:151], v[40:43]
    s_waitcnt lgkmcnt(0)
    s_barrier
    s_waitcnt lgkmcnt(7)
    v_mfma_f32_32x32x16_bf16 v[80:95], v[44:47], v[152:155], v[80:95]
    v_add_u32 v10, 0xe000, v10
    ds_read_b128 v[160:163], v6 offset:57344
    v_mfma_f32_32x32x16_bf16 v[96:111], v[48:51], v[152:155], v[96:111]
    ds_read_b64_tr_b16 v[68:69], v10 offset:16384
    ds_read_b64_tr_b16 v[70:71], v10 offset:17152
    ds_read_b64_tr_b16 v[72:73], v10 offset:16448
    v_mfma_f32_32x32x16_bf16 v[112:127], v[52:55], v[152:155], v[112:127]
    ds_read_b64_tr_b16 v[74:75], v10 offset:17216
    ds_read_b64_tr_b16 v[76:77], v10 offset:16512
    ds_read_b64_tr_b16 v[78:79], v10 offset:17280
    s_waitcnt lgkmcnt(7)
    v_mfma_f32_32x32x16_bf16 v[80:95], v[56:59], v[156:159], v[80:95]
    ds_read_b128 v[164:167], v7 offset:57344
    ds_read_b64_tr_b16 v[44:45], v10 offset:19456
    v_mfma_f32_32x32x16_bf16 v[96:111], v[60:63], v[156:159], v[96:111]
    ds_read_b64_tr_b16 v[46:47], v10 offset:20224
    ds_read_b64_tr_b16 v[48:49], v10 offset:19520
    v_mfma_f32_32x32x16_bf16 v[112:127], v[64:67], v[156:159], v[112:127]
    ds_read_b64_tr_b16 v[50:51], v10 offset:20288
    ds_read_b64_tr_b16 v[52:53], v10 offset:19584
    ds_read_b64_tr_b16 v[54:55], v10 offset:20352
    s_waitcnt lgkmcnt(7)
    v_mfma_f32_32x32x16_bf16 v[80:95], v[68:71], v[160:163], v[80:95]
    ds_read_b128 v[168:171], v8 offset:57344
    ds_read_b64_tr_b16 v[56:57], v10 offset:22528
    v_mfma_f32_32x32x16_bf16 v[96:111], v[72:75], v[160:163], v[96:111]
    ds_read_b64_tr_b16 v[58:59], v10 offset:23296
    ds_read_b64_tr_b16 v[60:61], v10 offset:22592
    v_mfma_f32_32x32x16_bf16 v[112:127], v[76:79], v[160:163], v[112:127]
    ds_read_b64_tr_b16 v[62:63], v10 offset:23360
    ds_read_b64_tr_b16 v[64:65], v10 offset:22656
    ds_read_b64_tr_b16 v[66:67], v10 offset:23424
    s_waitcnt lgkmcnt(7)
    v_mfma_f32_32x32x16_bf16 v[80:95], v[44:47], v[164:167], v[80:95]
    ds_read_b128 v[172:175], v9 offset:57344
    ds_read_b64_tr_b16 v[68:69], v10 offset:25600
    v_mfma_f32_32x32x16_bf16 v[96:111], v[48:51], v[164:167], v[96:111]
    ds_read_b64_tr_b16 v[70:71], v10 offset:26368
    ds_read_b64_tr_b16 v[72:73], v10 offset:25664
    v_mfma_f32_32x32x16_bf16 v[112:127], v[52:55], v[164:167], v[112:127]
    ds_read_b64_tr_b16 v[74:75], v10 offset:26432
    ds_read_b64_tr_b16 v[76:77], v10 offset:25728
    ds_read_b64_tr_b16 v[78:79], v10 offset:26496
    v_smfmac_f32_16x16x64_bf16 v[28:31], v[24:27], v[152:159], v17
    v_smfmac_f32_16x16x64_bf16 v[28:31], v[24:27], v[160:167], v17
    v_mfma_f32_4x4x4_16b_bf16 v[32:35], v[152:153], v[152:153], v[32:35]
    v_mfma_f32_4x4x4_16b_bf16 v[40:43], v[154:155], v[154:155], v[40:43]
    v_mfma_f32_4x4x4_16b_bf16 v[36:39], v[156:157], v[156:157], v[36:39]
    v_mfma_f32_4x4x4_16b_bf16 v[32:35], v[158:159], v[158:159], v[32:35]
    v_mfma_f32_4x4x4_16b_bf16 v[40:43], v[160:161], v[160:161], v[40:43]
    v_mfma_f32_4x4x4_16b_bf16 v[36:39], v[162:163], v[162:163], v[36:39]
    v_mfma_f32_4x4x4_16b_bf16 v[32:35], v[164:165], v[164:165], v[32:35]
    v_mfma_f32_4x4x4_16b_bf16 v[40:43], v[166:167], v[166:167], v[40:43]
    s_waitcnt lgkmcnt(0)
    s_barrier
    s_waitcnt lgkmcnt(7)
    v_mfma_f32_32x32x16_bf16 v[80:95], v[56:59], v[168:171], v[80:95]
    v_add_u32 v10, 0xffff2000, v10
    ds_read_b128 v[176:179], v6 offset:0
    v_mfma_f32_32x32x16_bf16 v[96:111], v[60:63], v[168:171], v[96:111]
    ds_read_b64_tr_b16 v[44:45], v10 offset:16384
    ds_read_b64_tr_b16 v[46:47], v10 offset:17152
    ds_read_b64_tr_b16 v[48:49], v10 offset:16448
    v_mfma_f32_32x32x16_bf16 v[112:127], v[64:67], v[168:171], v[112:127]
    ds_read_b64_tr_b16 v[50:51], v10 offset:17216
    ds_read_b64_tr_b16 v[52:53], v10 offset:16512
    ds_read_b64_tr_b16 v[54:55], v10 offset:17280
    s_waitcnt lgkmcnt(7)
    v_mfma_f32_32x32x16_bf16 v[80:95], v[68:71], v[172:175], v[80:95]
    ds_read_b128 v[180:183], v7 offset:0
    ds_read_b64_tr_b16 v[56:57], v10 offset:19456
    v_mfma_f32_32x32x16_bf16 v[96:111], v[72:75], v[172:175], v[96:111]
    ds_read_b64_tr_b16 v[58:59], v10 offset:20224
    ds_read_b64_tr_b16 v[60:61], v10 offset:19520
    v_mfma_f32_32x32x16_bf16 v[112:127], v[76:79], v[172:175], v[112:127]
    ds_read_b64_tr_b16 v[62:63], v10 offset:20288
    ds_read_b64_tr_b16 v[64:65], v10 offset:19584
    ds_read_b64_tr_b16 v[66:67], v10 offset:20352
    s_waitcnt lgkmcnt(7)
    v_mfma_f32_32x32x16_bf16 v[80:95], v[44:47], v[176:179], v[80:95]
    ds_read_b128 v[184:187], v8 offset:0
    ds_read_b64_tr_b16 v[68:69], v10 offset:22528
    v_mfma_f32_32x32x16_bf16 v[96:111], v[48:51], v[176:179], v[96:111]
    ds_read_b64_tr_b16 v[70:71], v10 offset:23296
    ds_read_b64_tr_b16 v[72:73], v10 offset:22592
    v_mfma_f32_32x32x16_bf16 v[112:127], v[52:55], v[176:179], v[112:127]
    ds_read_b64_tr_b16 v[74:75], v10 offset:23360
    ds_read_b64_tr_b16 v[76:77], v10 offset:22656
    ds_read_b64_tr_b16 v[78:79], v10 offset:23424
    s_waitcnt lgkmcnt(7)
    v_mfma_f32_32x32x16_bf16 v[80:95], v[56:59], v[180:183], v[80:95]
    ds_read_b128 v[188:191], v9 offset:0
    ds_read_b64_tr_b16 v[44:45], v10 offset:25600
    v_mfma_f32_32x32x16_bf16 v[96:111], v[60:63], v[180:183], v[96:111]
    ds_read_b64_tr_b16 v[46:47], v10 offset:26368
    ds_read_b64_tr_b16 v[48:49], v10 offset:25664
    v_mfma_f32_32x32x16_bf16 v[112:127], v[64:67], v[180:183], v[112:127]
    ds_read_b64_tr_b16 v[50:51], v10 offset:26432
    ds_read_b64_tr_b16 v[52:53], v10 offset:25728
    ds_read_b64_tr_b16 v[54:55], v10 offset:26496
    v_smfmac_f32_16x16x64_bf16 v[28:31], v[24:27], v[168:175], v17
    v_smfmac_f32_16x16x64_bf16 v[28:31], v[24:27], v[176:183], v17
    v_mfma_f32_4x4x4_16b_bf16 v[32:35], v[168:169], v[168:169], v[32:35]
    v_mfma_f32_4x4x4_16b_bf16 v[40:43], v[170:171], v[170:171], v[40:43]
    v_mfma_f32_4x4x4_16b_bf16 v[36:39], v[172:173], v[172:173], v[36:39]
    v_mfma_f32_4x4x4_16b_bf16 v[32:35], v[174:175], v[174:175], v[32:35]
    v_mfma_f32_4x4x4_16b_bf16 v[40:43], v[176:177], v[176:177], v[40:43]
    v_mfma_f32_4x4x4_16b_bf16 v[36:39], v[178:179], v[178:179], v[36:39]
    v_mfma_f32_4x4x4_16b_bf16 v[32:35], v[180:181], v[180:181], v[32:35]
    v_mfma_f32_4x4x4_16b_bf16 v[40:43], v[182:183], v[182:183], v[40:43]
    s_waitcnt lgkmcnt(0)
    s_barrier
    s_waitcnt lgkmcnt(7)
    v_mfma_f32_32x32x16_bf16 v[80:95], v[68:71], v[184:187], v[80:95]
    ds_read_b128 v[192:195], v6 offset:28672
    ds_read_b64_tr_b16 v[56:57], v10 offset:45056
    v_mfma_f32_32x32x16_bf16 v[96:111], v[72:75], v[184:187], v[96:111]
    ds_read_b64_tr_b16 v[58:59], v10 offset:45824
    ds_read_b64_tr_b16 v[60:61], v10 offset:45120
    v_mfma_f32_32x32x16_bf16 v[112:127], v[76:79], v[184:187], v[112:127]
    ds_read_b64_tr_b16 v[62:63], v10 offset:45888
    ds_read_b64_tr_b16 v[64:65], v10 offset:45184
    ds_read_b64_tr_b16 v[66:67], v10 offset:45952
    s_waitcnt lgkmcnt(7)
    v_mfma_f32_32x32x16_bf16 v[80:95], v[44:47], v[188:191], v[80:95]
    ds_read_b128 v[196:199], v7 offset:28672
    ds_read_b64_tr_b16 v[68:69], v10 offset:48128
    v_mfma_f32_32x32x16_bf16 v[96:111], v[48:51], v[188:191], v[96:111]
    ds_read_b64_tr_b16 v[70:71], v10 offset:48896
    ds_read_b64_tr_b16 v[72:73], v10 offset:48192
    v_mfma_f32_32x32x16_bf16 v[112:127], v[52:55], v[188:191], v[112:127]
    ds_read_b64_tr_b16 v[74:75], v10 offset:48960
    ds_read_b64_tr_b16 v[76:77], v10 offset:48256
    ds_read_b64_tr_b16 v[78:79], v10 offset:49024
    s_waitcnt lgkmcnt(7)
    v_mfma_f32_32x32x16_bf16 v[80:95], v[56:59], v[192:195], v[80:95]
    ds_read_b128 v[200:203], v8 offset:28672
    ds_read_b64_tr_b16 v[44:45], v10 offset:51200
    v_mfma_f32_32x32x16_bf16 v[96:111], v[60:63], v[192:195], v[96:111]
    ds_read_b64_tr_b16 v[46:47], v10 offset:51968
    ds_read_b64_tr_b16 v[48:49], v10 offset:51264
    v_mfma_f32_32x32x16_bf16 v[112:127], v[64:67], v[192:195], v[112:127]
    ds_read_b64_tr_b16 v[50:51], v10 offset:52032
    ds_read_b64_tr_b16 v[52:53], v10 offset:51328
    ds_read_b64_tr_b16 v[54:55], v10 offset:52096
    s_waitcnt lgkmcnt(7)
    v_mfma_f32_32x32x16_bf16 v[80:95], v[68:71], v[196:199], v[80:95]
    ds_read_b128 v[204:207], v9 offset:28672
    ds_read_b64_tr_b16 v[56:57], v10 offset:54272
    v_mfma_f32_32x32x16_bf16 v[96:111], v[72:75], v[196:199], v[96:111]
    ds_read_b64_tr_b16 v[58:59], v10 offset:55040
    ds_read_b64_tr_b16 v[60:61], v10 offset:54336
    v_mfma_f32_32x32x16_bf16 v[112:127], v[76:79], v[196:199], v[112:127]
    ds_read_b64_tr_b16 v[62:63], v10 offset:55104
    ds_read_b64_tr_b16 v[64:65], v10 offset:54400
    ds_read_b64_tr_b16 v[66:67], v10 offset:55168
    v_smfmac_f32_16x16x64_bf16 v[28:31], v[24:27], v[184:191], v17
    v_smfmac_f32_16x16x64_bf16 v[28:31], v[24:27], v[192:199], v17
    v_mfma_f32_4x4x4_16b_bf16 v[32:35], v[184:185], v[184:185], v[32:35]
    v_mfma_f32_4x4x4_16b_bf16 v[40:43], v[186:187], v[186:187], v[40:43]
    v_mfma_f32_4x4x4_16b_bf16 v[36:39], v[188:189], v[188:189], v[36:39]
    v_mfma_f32_4x4x4_16b_bf16 v[32:35], v[190:191], v[190:191], v[32:35]
    v_mfma_f32_4x4x4_16b_bf16 v[40:43], v[192:193], v[192:193], v[40:43]
    v_mfma_f32_4x4x4_16b_bf16 v[36:39], v[194:195], v[194:195], v[36:39]
    v_mfma_f32_4x4x4_16b_bf16 v[32:35], v[196:197], v[196:197], v[32:35]
    v_mfma_f32_4x4x4_16b_bf16 v[40:43], v[198:199], v[198:199], v[40:43]
    s_waitcnt lgkmcnt(0)
    s_barrier
    s_waitcnt lgkmcnt(7)
    v_mfma_f32_32x32x16_bf16 v[80:95], v[44:47], v[200:203], v[80:95]
    v_add_u32 v10, 0xe000, v10
    ds_read_b128 v[208:211], v6 offset:57344
    v_mfma_f32_32x32x16_bf16 v[96:111], v[48:51], v[200:203], v[96:111]
    ds_read_b64_tr_b16 v[68:69], v10 offset:16384
    ds_read_b64_tr_b16 v[70:71], v10 offset:17152
    ds_read_b64_tr_b16 v[72:73], v10 offset:16448
    v_mfma_f32_32x32x16_bf16 v[112:127], v[52:55], v[200:203], v[112:127]
    ds_read_b64_tr_b16 v[74:75], v10 offset:17216
    ds_read_b64_tr_b16 v[76:77], v10 offset:16512
    ds_read_b64_tr_b16 v[78:79], v10 offset:17280
    s_waitcnt lgkmcnt(7)
    v_mfma_f32_32x32x16_bf16 v[80:95], v[56:59], v[204:207], v[80:95]
    ds_read_b128 v[212:215], v7 offset:57344
    ds_read_b64_tr_b16 v[44:45], v10 offset:19456
    v_mfma_f32_32x32x16_bf16 v[96:111], v[60:63], v[204:207], v[96:111]
    ds_read_b64_tr_b16 v[46:47], v10 offset:20224
    ds_read_b64_tr_b16 v[48:49], v10 offset:19520
    v_mfma_f32_32x32x16_bf16 v[112:127], v[64:67], v[204:207], v[112:127]
    ds_read_b64_tr_b16 v[50:51], v10 offset:20288
    ds_read_b64_tr_b16 v[52:53], v10 offset:19584
    ds_read_b64_tr_b16 v[54:55], v10 offset:20352
    s_waitcnt lgkmcnt(7)
    v_mfma_f32_32x32x16_bf16 v[80:95], v[68:71], v[208:211], v[80:95]
    ds_read_b128 v[216:219], v8 offset:57344
    ds_read_b64_tr_b16 v[56:57], v10 offset:22528
    v_mfma_f32_32x32x16_bf16 v[96:111], v[72:75], v[208:211], v[96:111]
    ds_read_b64_tr_b16 v[58:59], v10 offset:23296
    ds_read_b64_tr_b16 v[60:61], v10 offset:22592
    v_mfma_f32_32x32x16_bf16 v[112:127], v[76:79], v[208:211], v[112:127]
    ds_read_b64_tr_b16 v[62:63], v10 offset:23360
    ds_read_b64_tr_b16 v[64:65], v10 offset:22656
    ds_read_b64_tr_b16 v[66:67], v10 offset:23424
    s_waitcnt lgkmcnt(7)
    v_mfma_f32_32x32x16_bf16 v[80:95], v[44:47], v[212:215], v[80:95]
    ds_read_b128 v[220:223], v9 offset:57344
    ds_read_b64_tr_b16 v[68:69], v10 offset:25600
    v_mfma_f32_32x32x16_bf16 v[96:111], v[48:51], v[212:215], v[96:111]
    ds_read_b64_tr_b16 v[70:71], v10 offset:26368
    ds_read_b64_tr_b16 v[72:73], v10 offset:25664
    v_mfma_f32_32x32x16_bf16 v[112:127], v[52:55], v[212:215], v[112:127]
    ds_read_b64_tr_b16 v[74:75], v10 offset:26432
    ds_read_b64_tr_b16 v[76:77], v10 offset:25728
    ds_read_b64_tr_b16 v[78:79], v10 offset:26496
    v_smfmac_f32_16x16x64_bf16 v[28:31], v[24:27], v[200:207], v17
    v_smfmac_f32_16x16x64_bf16 v[28:31], v[24:27], v[208:215], v17
    v_mfma_f32_4x4x4_16b_bf16 v[32:35], v[200:201], v[200:201], v[32:35]
    v_mfma_f32_4x4x4_16b_bf16 v[40:43], v[202:203], v[202:203], v[40:43]
    v_mfma_f32_4x4x4_16b_bf16 v[36:39], v[204:205], v[204:205], v[36:39]
    v_mfma_f32_4x4x4_16b_bf16 v[32:35], v[206:207], v[206:207], v[32:35]
    v_mfma_f32_4x4x4_16b_bf16 v[40:43], v[208:209], v[208:209], v[40:43]
    v_mfma_f32_4x4x4_16b_bf16 v[36:39], v[210:211], v[210:211], v[36:39]
    v_mfma_f32_4x4x4_16b_bf16 v[32:35], v[212:213], v[212:213], v[32:35]
    v_mfma_f32_4x4x4_16b_bf16 v[40:43], v[214:215], v[214:215], v[40:43]
    s_waitcnt lgkmcnt(0)
    s_barrier
    s_waitcnt lgkmcnt(7)
    v_mfma_f32_32x32x16_bf16 v[80:95], v[56:59], v[216:219], v[80:95]
    v_add_u32 v10, 0xffff2000, v10
    ds_read_b128 v[224:227], v6 offset:0
    v_mfma_f32_32x32x16_bf16 v[96:111], v[60:63], v[216:219], v[96:111]
    ds_read_b64_tr_b16 v[44:45], v10 offset:16384
    ds_read_b64_tr_b16 v[46:47], v10 offset:17152
    ds_read_b64_tr_b16 v[48:49], v10 offset:16448
    v_mfma_f32_32x32x16_bf16 v[112:127], v[64:67], v[216:219], v[112:127]
    ds_read_b64_tr_b16 v[50:51], v10 offset:17216
    ds_read_b64_tr_b16 v[52:53], v10 offset:16512
    ds_read_b64_tr_b16 v[54:55], v10 offset:17280
    s_waitcnt lgkmcnt(7)
    v_mfma_f32_32x32x16_bf16 v[80:95], v[68:71], v[220:223], v[80:95]
    ds_read_b128 v[228:231], v7 offset:0
    ds_read_b64_tr_b16 v[56:57], v10 offset:19456
    v_mfma_f32_32x32x16_bf16 v[96:111], v[72:75], v[220:223], v[96:111]
    ds_read_b64_tr_b16 v[58:59], v10 offset:20224
    ds_read_b64_tr_b16 v[60:61], v10 offset:19520
    v_mfma_f32_32x32x16_bf16 v[112:127], v[76:79], v[220:223], v[112:127]
    ds_read_b64_tr_b16 v[62:63], v10 offset:20288
    ds_read_b64_tr_b16 v[64:65], v10 offset:19584
    ds_read_b64_tr_b16 v[66:67], v10 offset:20352
    s_waitcnt lgkmcnt(7)
    v_mfma_f32_32x32x16_bf16 v[80:95], v[44:47], v[224:227], v[80:95]
    ds_read_b128 v[232:235], v8 offset:0
    ds_read_b64_tr_b16 v[68:69], v10 offset:22528
    v_mfma_f32_32x32x16_bf16 v[96:111], v[48:51], v[224:227], v[96:111]
    ds_read_b64_tr_b16 v[70:71], v10 offset:23296
    ds_read_b64_tr_b16 v[72:73], v10 offset:22592
    v_mfma_f32_32x32x16_bf16 v[112:127], v[52:55], v[224:227], v[112:127]
    ds_read_b64_tr_b16 v[74:75], v10 offset:23360
    ds_read_b64_tr_b16 v[76:77], v10 offset:22656
    ds_read_b64_tr_b16 v[78:79], v10 offset:23424
    s_waitcnt lgkmcnt(7)
    v_mfma_f32_32x32x16_bf16 v[80:95], v[56:59], v[228:231], v[80:95]
    ds_read_b128 v[236:239], v9 offset:0
    ds_read_b64_tr_b16 v[44:45], v10 offset:25600
    v_mfma_f32_32x32x16_bf16 v[96:111], v[60:63], v[228:231], v[96:111]
    ds_read_b64_tr_b16 v[46:47], v10 offset:26368
    ds_read_b64_tr_b16 v[48:49], v10 offset:25664
    v_mfma_f32_32x32x16_bf16 v[112:127], v[64:67], v[228:231], v[112:127]
    ds_read_b64_tr_b16 v[50:51], v10 offset:26432
    ds_read_b64_tr_b16 v[52:53], v10 offset:25728
    ds_read_b64_tr_b16 v[54:55], v10 offset:26496
    v_smfmac_f32_16x16x64_bf16 v[28:31], v[24:27], v[216:223], v17
    v_smfmac_f32_16x16x64_bf16 v[28:31], v[24:27], v[224:231], v17
    v_mfma_f32_4x4x4_16b_bf16 v[32:35], v[216:217], v[216:217], v[32:35]
    v_mfma_f32_4x4x4_16b_bf16 v[40:43], v[218:219], v[218:219], v[40:43]
    v_mfma_f32_4x4x4_16b_bf16 v[36:39], v[220:221], v[220:221], v[36:39]
    v_mfma_f32_4x4x4_16b_bf16 v[32:35], v[222:223], v[222:223], v[32:35]
    v_mfma_f32_4x4x4_16b_bf16 v[40:43], v[224:225], v[224:225], v[40:43]
    v_mfma_f32_4x4x4_16b_bf16 v[36:39], v[226:227], v[226:227], v[36:39]
    v_mfma_f32_4x4x4_16b_bf16 v[32:35], v[228:229], v[228:229], v[32:35]
    v_mfma_f32_4x4x4_16b_bf16 v[40:43], v[230:231], v[230:231], v[40:43]
    s_waitcnt lgkmcnt(0)
    s_barrier
    s_waitcnt lgkmcnt(7)
    v_mfma_f32_32x32x16_bf16 v[80:95], v[68:71], v[232:235], v[80:95]
    ds_read_b128 v[240:243], v6 offset:28672
    ds_read_b64_tr_b16 v[56:57], v10 offset:45056
    v_mfma_f32_32x32x16_bf16 v[96:111], v[72:75], v[232:235], v[96:111]
    ds_read_b64_tr_b16 v[58:59], v10 offset:45824
    ds_read_b64_tr_b16 v[60:61], v10 offset:45120
    v_mfma_f32_32x32x16_bf16 v[112:127], v[76:79], v[232:235], v[112:127]
    ds_read_b64_tr_b16 v[62:63], v10 offset:45888
    ds_read_b64_tr_b16 v[64:65], v10 offset:45184
    ds_read_b64_tr_b16 v[66:67], v10 offset:45952
    s_waitcnt lgkmcnt(7)
    v_mfma_f32_32x32x16_bf16 v[80:95], v[44:47], v[236:239], v[80:95]
    ds_read_b128 v[244:247], v7 offset:28672
    ds_read_b64_tr_b16 v[68:69], v10 offset:48128
    v_mfma_f32_32x32x16_bf16 v[96:111], v[48:51], v[236:239], v[96:111]
    ds_read_b64_tr_b16 v[70:71], v10 offset:48896
    ds_read_b64_tr_b16 v[72:73], v10 offset:48192
    v_mfma_f32_32x32x16_bf16 v[112:127], v[52:55], v[236:239], v[112:127]
    ds_read_b64_tr_b16 v[74:75], v10 offset:48960
    ds_read_b64_tr_b16 v[76:77], v10 offset:48256
    ds_read_b64_tr_b16 v[78:79], v10 offset:49024
    s_waitcnt lgkmcnt(7)
    v_mfma_f32_32x32x16_bf16 v[80:95], v[56:59], v[240:243], v[80:95]
    ds_read_b128 v[248:251], v8 offset:28672
    ds_read_b64_tr_b16 v[44:45], v10 offset:51200
    v_mfma_f32_32x32x16_bf16 v[96:111], v[60:63], v[240:243], v[96:111]
    ds_read_b64_tr_b16 v[46:47], v10 offset:51968
    ds_read_b64_tr_b16 v[48:49], v10 offset:51264
    v_mfma_f32_32x32x16_bf16 v[112:127], v[64:67], v[240:243], v[112:127]
    ds_read_b64_tr_b16 v[50:51], v10 offset:52032
    ds_read_b64_tr_b16 v[52:53], v10 offset:51328
    ds_read_b64_tr_b16 v[54:55], v10 offset:52096
    s_waitcnt lgkmcnt(7)
    v_mfma_f32_32x32x16_bf16 v[80:95], v[68:71], v[244:247], v[80:95]
    ds_read_b128 v[252:255], v9 offset:28672
    ds_read_b64_tr_b16 v[56:57], v10 offset:54272
    v_mfma_f32_32x32x16_bf16 v[96:111], v[72:75], v[244:247], v[96:111]
    ds_read_b64_tr_b16 v[58:59], v10 offset:55040
    ds_read_b64_tr_b16 v[60:61], v10 offset:54336
    v_mfma_f32_32x32x16_bf16 v[112:127], v[76:79], v[244:247], v[112:127]
    ds_read_b64_tr_b16 v[62:63], v10 offset:55104
    ds_read_b64_tr_b16 v[64:65], v10 offset:54400
    ds_read_b64_tr_b16 v[66:67], v10 offset:55168
    s_waitcnt lgkmcnt(7)
    v_mfma_f32_32x32x16_bf16 v[80:95], v[44:47], v[248:251], v[80:95]
    v_mfma_f32_32x32x16_bf16 v[96:111], v[48:51], v[248:251], v[96:111]
    v_mfma_f32_32x32x16_bf16 v[112:127], v[52:55], v[248:251], v[112:127]
    s_waitcnt lgkmcnt(0)
    v_smfmac_f32_16x16x64_bf16 v[28:31], v[24:27], v[232:239], v17
    v_smfmac_f32_16x16x64_bf16 v[28:31], v[24:27], v[240:247], v17
    v_smfmac_f32_16x16x64_bf16 v[28:31], v[24:27], v[248:255], v17
    v_mfma_f32_4x4x4_16b_bf16 v[32:35], v[232:233], v[232:233], v[32:35]
    v_mfma_f32_4x4x4_16b_bf16 v[40:43], v[234:235], v[234:235], v[40:43]
    v_mfma_f32_4x4x4_16b_bf16 v[36:39], v[236:237], v[236:237], v[36:39]
    v_mfma_f32_4x4x4_16b_bf16 v[32:35], v[238:239], v[238:239], v[32:35]
    v_mfma_f32_4x4x4_16b_bf16 v[40:43], v[240:241], v[240:241], v[40:43]
    v_mfma_f32_4x4x4_16b_bf16 v[36:39], v[242:243], v[242:243], v[36:39]
    v_mfma_f32_4x4x4_16b_bf16 v[32:35], v[244:245], v[244:245], v[32:35]
    v_mfma_f32_4x4x4_16b_bf16 v[40:43], v[246:247], v[246:247], v[40:43]
    v_mfma_f32_4x4x4_16b_bf16 v[36:39], v[248:249], v[248:249], v[36:39]
    v_mfma_f32_4x4x4_16b_bf16 v[32:35], v[250:251], v[250:251], v[32:35]
    v_mfma_f32_4x4x4_16b_bf16 v[40:43], v[252:253], v[252:253], v[40:43]
    v_mfma_f32_4x4x4_16b_bf16 v[36:39], v[254:255], v[254:255], v[36:39]
    v_mfma_f32_32x32x16_bf16 v[80:95], v[56:59], v[252:255], v[80:95]
    v_mfma_f32_32x32x16_bf16 v[96:111], v[60:63], v[252:255], v[96:111]
    v_mfma_f32_32x32x16_bf16 v[112:127], v[64:67], v[252:255], v[112:127]
    v_and_b32 v2, 3, v1
    v_cmp_eq_u32 vcc, 1, v2
    v_cmp_eq_u32 s[64:65], 2, v2
    v_cmp_eq_u32 s[66:67], 3, v2
    v_add_f32 v32, v32, v40
    v_add_f32 v33, v33, v41
    v_add_f32 v34, v34, v42
    v_add_f32 v35, v35, v43
    v_add_f32 v32, v32, v36
    v_add_f32 v33, v33, v37
    v_add_f32 v34, v34, v38
    v_add_f32 v35, v35, v39
    v_cndmask_b32 v40, v32, v33, vcc
    v_cndmask_b32 v40, v40, v34, s[64:65]
    v_cndmask_b32 v40, v40, v35, s[66:67]
    v_and_b32 v3, 16, v1
    v_cmp_eq_u32 s[64:65], 0, v3
    v_mov_b32 v41, v40
    v_cmp_gt_u32 vcc, 32, v1
    v_mov_b32 v39, 0
    v_add_f32 v28, v28, v29
    v_add_f32 v30, v30, v31
    v_permlane32_swap_b32 v40, v41
    v_cndmask_b32 v32, v30, v28, s[64:65]
    v_add_f32 v33, v40, v41
    v_mul_f32 v32, 0xbb000000, v32
    v_mul_f32 v33, 0x3b000000, v33
    v_fma_f32 v33, -v32, v32, v33
    v_max_f32 v33, 0, v33
    v_add_f32 v33, 0x3727c5ac, v33
    v_rsq_f32 v18, v33
    v_cndmask_b32 v32, 0, v32, vcc
    v_mul_f32 v19, v33, v18
    v_cvt_pk_bf16_f32 v2, v32, v32
    v_cndmask_b32 v33, 0, v19, vcc
    v_and_b32 v3, 0xffff0000, v2
    v_sub_f32 v3, v32, v3
    v_cvt_pk_bf16_f32 v36, v32, v3
    v_cvt_pk_bf16_f32 v37, v32, v33
    v_and_b32 v3, 0xffff0000, v37
    v_sub_f32 v3, v33, v3
    v_cvt_pk_bf16_f32 v38, v3, 0
    v_mul_f32 v20, 0x3eb8aa3b, v18
    s_barrier
    ds_read_b128 v[44:47], v14 offset:0
    ds_read_b128 v[48:51], v14 offset:512
    ds_read_b128 v[52:55], v14 offset:1024
    s_waitcnt lgkmcnt(2)
    v_mfma_f32_32x32x16_bf16 v[80:95], v[44:47], v[36:39], v[80:95]
    s_waitcnt lgkmcnt(1)
    v_mfma_f32_32x32x16_bf16 v[96:111], v[48:51], v[36:39], v[96:111]
    s_waitcnt lgkmcnt(0)
    v_mfma_f32_32x32x16_bf16 v[112:127], v[52:55], v[36:39], v[112:127]
    s_nop 7
    s_cmp_ge_u32 s71, 32
    s_cbranch_scc1 L_p1v_13
    s_cmp_lt_u32 s71, 16
    s_cselect_b64 vcc, -1, 0
    v_cndmask_b32 v4, v18, v20, vcc
    v_pk_mul_f32 v[80:81], v[80:81], v[4:5] op_sel_hi:[1,0]
    v_pk_mul_f32 v[82:83], v[82:83], v[4:5] op_sel_hi:[1,0]
    v_pk_mul_f32 v[84:85], v[84:85], v[4:5] op_sel_hi:[1,0]
    v_pk_mul_f32 v[86:87], v[86:87], v[4:5] op_sel_hi:[1,0]
    v_pk_mul_f32 v[88:89], v[88:89], v[4:5] op_sel_hi:[1,0]
    v_pk_mul_f32 v[90:91], v[90:91], v[4:5] op_sel_hi:[1,0]
    v_pk_mul_f32 v[92:93], v[92:93], v[4:5] op_sel_hi:[1,0]
    v_pk_mul_f32 v[94:95], v[94:95], v[4:5] op_sel_hi:[1,0]
    v_cvt_pk_bf16_f32 v56, v80, v81
    v_cvt_pk_bf16_f32 v57, v82, v83
    v_cvt_pk_bf16_f32 v58, v84, v85
    v_cvt_pk_bf16_f32 v59, v86, v87
    v_cvt_pk_bf16_f32 v60, v88, v89
    v_cvt_pk_bf16_f32 v61, v90, v91
    v_cvt_pk_bf16_f32 v62, v92, v93
    v_cvt_pk_bf16_f32 v63, v94, v95
    buffer_store_dwordx4 v[56:59], v11, s[16:19], s72 offen sc1
    buffer_store_dwordx4 v[60:63], v11, s[16:19], s73 offen sc1
    s_cmp_lt_u32 s71, 15
    s_cselect_b64 vcc, -1, 0
    v_cndmask_b32 v4, v18, v20, vcc
    v_pk_mul_f32 v[96:97], v[96:97], v[4:5] op_sel_hi:[1,0]
    v_pk_mul_f32 v[98:99], v[98:99], v[4:5] op_sel_hi:[1,0]
    v_pk_mul_f32 v[100:101], v[100:101], v[4:5] op_sel_hi:[1,0]
    v_pk_mul_f32 v[102:103], v[102:103], v[4:5] op_sel_hi:[1,0]
    v_pk_mul_f32 v[104:105], v[104:105], v[4:5] op_sel_hi:[1,0]
    v_pk_mul_f32 v[106:107], v[106:107], v[4:5] op_sel_hi:[1,0]
    v_pk_mul_f32 v[108:109], v[108:109], v[4:5] op_sel_hi:[1,0]
    v_pk_mul_f32 v[110:111], v[110:111], v[4:5] op_sel_hi:[1,0]
    v_cvt_pk_bf16_f32 v64, v96, v97
    v_cvt_pk_bf16_f32 v65, v98, v99
    v_cvt_pk_bf16_f32 v66, v100, v101
    v_cvt_pk_bf16_f32 v67, v102, v103
    v_cvt_pk_bf16_f32 v68, v104, v105
    v_cvt_pk_bf16_f32 v69, v106, v107
    v_cvt_pk_bf16_f32 v70, v108, v109
    v_cvt_pk_bf16_f32 v71, v110, v111
    buffer_store_dwordx4 v[64:67], v11, s[16:19], s74 offen sc1
    buffer_store_dwordx4 v[68:71], v11, s[16:19], s75 offen sc1
    s_cmp_lt_u32 s71, 14
    s_cselect_b64 vcc, -1, 0
    v_cndmask_b32 v4, v18, v20, vcc
    v_pk_mul_f32 v[112:113], v[112:113], v[4:5] op_sel_hi:[1,0]
    v_pk_mul_f32 v[114:115], v[114:115], v[4:5] op_sel_hi:[1,0]
    v_pk_mul_f32 v[116:117], v[116:117], v[4:5] op_sel_hi:[1,0]
    v_pk_mul_f32 v[118:119], v[118:119], v[4:5] op_sel_hi:[1,0]
    v_pk_mul_f32 v[120:121], v[120:121], v[4:5] op_sel_hi:[1,0]
    v_pk_mul_f32 v[122:123], v[122:123], v[4:5] op_sel_hi:[1,0]
    v_pk_mul_f32 v[124:125], v[124:125], v[4:5] op_sel_hi:[1,0]
    v_pk_mul_f32 v[126:127], v[126:127], v[4:5] op_sel_hi:[1,0]
    v_cvt_pk_bf16_f32 v72, v112, v113
    v_cvt_pk_bf16_f32 v73, v114, v115
    v_cvt_pk_bf16_f32 v74, v116, v117
    v_cvt_pk_bf16_f32 v75, v118, v119
    v_cvt_pk_bf16_f32 v76, v120, v121
    v_cvt_pk_bf16_f32 v77, v122, v123
    v_cvt_pk_bf16_f32 v78, v124, v125
    v_cvt_pk_bf16_f32 v79, v126, v127
    s_cmp_lt_u32 s71, 30
    s_cbranch_scc1 L_p1k_15
    ds_write_b64 v12, v[72:73] offset:0
    ds_write_b64 v12, v[74:75] offset:16
    ds_write_b64 v12, v[76:77] offset:1024
    ds_write_b64 v12, v[78:79] offset:1040
    ds_read_b64_tr_b16 v[72:73], v13 offset:0
    ds_read_b64_tr_b16 v[74:75], v13 offset:128
    ds_read_b64_tr_b16 v[76:77], v13 offset:1024
    ds_read_b64_tr_b16 v[78:79], v13 offset:1152
    s_waitcnt lgkmcnt(0)
L_p1k_15:
    buffer_store_dwordx4 v[72:75], v11, s[16:19], s76 offen sc1
    buffer_store_dwordx4 v[76:79], v11, s[16:19], s77 offen sc1
    s_branch L_p1q_14
L_p1v_13:
    v_mul_f32 v80, v80, v18
    v_mul_f32 v81, v81, v18
    v_mul_f32 v82, v82, v18
    v_mul_f32 v83, v83, v18
    v_mul_f32 v84, v84, v18
    v_mul_f32 v85, v85, v18
    v_mul_f32 v86, v86, v18
    v_mul_f32 v87, v87, v18
    v_mul_f32 v88, v88, v18
    v_mul_f32 v89, v89, v18
    v_mul_f32 v90, v90, v18
    v_mul_f32 v91, v91, v18
    v_mul_f32 v92, v92, v18
    v_mul_f32 v93, v93, v18
    v_mul_f32 v94, v94, v18
    v_mul_f32 v95, v95, v18
    v_cvt_pk_bf16_f32 v56, v80, v81
    v_cvt_pk_bf16_f32 v57, v82, v83
    v_cvt_pk_bf16_f32 v58, v84, v85
    v_cvt_pk_bf16_f32 v59, v86, v87
    v_cvt_pk_bf16_f32 v60, v88, v89
    v_cvt_pk_bf16_f32 v61, v90, v91
    v_cvt_pk_bf16_f32 v62, v92, v93
    v_cvt_pk_bf16_f32 v63, v94, v95
    ds_write_b64 v12, v[56:57] offset:0
    ds_write_b64 v12, v[58:59] offset:16
    ds_write_b64 v12, v[60:61] offset:1024
    ds_write_b64 v12, v[62:63] offset:1040
    ds_read_b64_tr_b16 v[56:57], v13 offset:0
    ds_read_b64_tr_b16 v[58:59], v13 offset:128
    ds_read_b64_tr_b16 v[60:61], v13 offset:1024
    ds_read_b64_tr_b16 v[62:63], v13 offset:1152
    v_mul_f32 v96, v96, v18
    v_mul_f32 v97, v97, v18
    v_mul_f32 v98, v98, v18
    v_mul_f32 v99, v99, v18
    v_mul_f32 v100, v100, v18
    v_mul_f32 v101, v101, v18
    v_mul_f32 v102, v102, v18
    v_mul_f32 v103, v103, v18
    v_mul_f32 v104, v104, v18
    v_mul_f32 v105, v105, v18
    v_mul_f32 v106, v106, v18
    v_mul_f32 v107, v107, v18
    v_mul_f32 v108, v108, v18
    v_mul_f32 v109, v109, v18
    v_mul_f32 v110, v110, v18
    v_mul_f32 v111, v111, v18
    v_cvt_pk_bf16_f32 v64, v96, v97
    v_cvt_pk_bf16_f32 v65, v98, v99
    v_cvt_pk_bf16_f32 v66, v100, v101
    v_cvt_pk_bf16_f32 v67, v102, v103
    v_cvt_pk_bf16_f32 v68, v104, v105
    v_cvt_pk_bf16_f32 v69, v106, v107
    v_cvt_pk_bf16_f32 v70, v108, v109
    v_cvt_pk_bf16_f32 v71, v110, v111
    s_waitcnt lgkmcnt(0)
    buffer_store_dwordx4 v[56:59], v11, s[16:19], s72 offen sc1
    buffer_store_dwordx4 v[60:63], v11, s[16:19], s73 offen sc1
    ds_write_b64 v12, v[64:65] offset:2048
    ds_write_b64 v12, v[66:67] offset:2064
    ds_write_b64 v12, v[68:69] offset:3072
    ds_write_b64 v12, v[70:71] offset:3088
    ds_read_b64_tr_b16 v[64:65], v13 offset:2048
    ds_read_b64_tr_b16 v[66:67], v13 offset:2176
    ds_read_b64_tr_b16 v[68:69], v13 offset:3072
    ds_read_b64_tr_b16 v[70:71], v13 offset:3200
    v_mul_f32 v112, v112, v18
    v_mul_f32 v113, v113, v18
    v_mul_f32 v114, v114, v18
    v_mul_f32 v115, v115, v18
    v_mul_f32 v116, v116, v18
    v_mul_f32 v117, v117, v18
    v_mul_f32 v118, v118, v18
    v_mul_f32 v119, v119, v18
    v_mul_f32 v120, v120, v18
    v_mul_f32 v121, v121, v18
    v_mul_f32 v122, v122, v18
    v_mul_f32 v123, v123, v18
    v_mul_f32 v124, v124, v18
    v_mul_f32 v125, v125, v18
    v_mul_f32 v126, v126, v18
    v_mul_f32 v127, v127, v18
    v_cvt_pk_bf16_f32 v72, v112, v113
    v_cvt_pk_bf16_f32 v73, v114, v115
    v_cvt_pk_bf16_f32 v74, v116, v117
    v_cvt_pk_bf16_f32 v75, v118, v119
    v_cvt_pk_bf16_f32 v76, v120, v121
    v_cvt_pk_bf16_f32 v77, v122, v123
    v_cvt_pk_bf16_f32 v78, v124, v125
    v_cvt_pk_bf16_f32 v79, v126, v127
    s_waitcnt lgkmcnt(0)
    buffer_store_dwordx4 v[64:67], v11, s[16:19], s74 offen sc1
    buffer_store_dwordx4 v[68:71], v11, s[16:19], s75 offen sc1
    ds_write_b64 v12, v[72:73] offset:4096
    ds_write_b64 v12, v[74:75] offset:4112
    ds_write_b64 v12, v[76:77] offset:5120
    ds_write_b64 v12, v[78:79] offset:5136
    ds_read_b64_tr_b16 v[72:73], v13 offset:4096
    ds_read_b64_tr_b16 v[74:75], v13 offset:4224
    ds_read_b64_tr_b16 v[76:77], v13 offset:5120
    ds_read_b64_tr_b16 v[78:79], v13 offset:5248
    s_waitcnt lgkmcnt(0)
    buffer_store_dwordx4 v[72:75], v11, s[16:19], s76 offen sc1
    buffer_store_dwordx4 v[76:79], v11, s[16:19], s77 offen sc1
L_p1q_14:
    s_mov_b32 s81, 0
    v_add_u32 v10, 0x15000, v10
    ds_read_b64_tr_b16 v[44:45], v10 offset:0
    ds_read_b64_tr_b16 v[46:47], v10 offset:768
    ds_read_b64_tr_b16 v[48:49], v10 offset:64
    ds_read_b64_tr_b16 v[50:51], v10 offset:832
    ds_read_b64_tr_b16 v[52:53], v10 offset:128
    ds_read_b64_tr_b16 v[54:55], v10 offset:896
    ds_read_b64_tr_b16 v[56:57], v10 offset:3072
    ds_read_b64_tr_b16 v[58:59], v10 offset:3840
    ds_read_b64_tr_b16 v[60:61], v10 offset:3136
    ds_read_b64_tr_b16 v[62:63], v10 offset:3904
    ds_read_b64_tr_b16 v[64:65], v10 offset:3200
    ds_read_b64_tr_b16 v[66:67], v10 offset:3968
    s_waitcnt lgkmcnt(6)
    v_mfma_f32_32x32x16_bf16 v[80:95], v[44:47], v[128:131], 0
    ds_read_b64_tr_b16 v[68:69], v10 offset:6144
    ds_read_b64_tr_b16 v[70:71], v10 offset:6912
    v_mfma_f32_32x32x16_bf16 v[96:111], v[48:51], v[128:131], 0
    ds_read_b64_tr_b16 v[72:73], v10 offset:6208
    ds_read_b64_tr_b16 v[74:75], v10 offset:6976
    v_mfma_f32_32x32x16_bf16 v[112:127], v[52:55], v[128:131], 0
    ds_read_b64_tr_b16 v[76:77], v10 offset:6272
    ds_read_b64_tr_b16 v[78:79], v10 offset:7040
    s_waitcnt lgkmcnt(6)
    v_mfma_f32_32x32x16_bf16 v[80:95], v[56:59], v[132:135], v[80:95]
    ds_read_b64_tr_b16 v[44:45], v10 offset:9216
    ds_read_b64_tr_b16 v[46:47], v10 offset:9984
    v_mfma_f32_32x32x16_bf16 v[96:111], v[60:63], v[132:135], v[96:111]
    ds_read_b64_tr_b16 v[48:49], v10 offset:9280
    ds_read_b64_tr_b16 v[50:51], v10 offset:10048
    v_mfma_f32_32x32x16_bf16 v[112:127], v[64:67], v[132:135], v[112:127]
    ds_read_b64_tr_b16 v[52:53], v10 offset:9344
    ds_read_b64_tr_b16 v[54:55], v10 offset:10112
    s_waitcnt lgkmcnt(6)
    v_mfma_f32_32x32x16_bf16 v[80:95], v[68:71], v[136:139], v[80:95]
    ds_read_b64_tr_b16 v[56:57], v10 offset:12288
    ds_read_b64_tr_b16 v[58:59], v10 offset:13056
    v_mfma_f32_32x32x16_bf16 v[96:111], v[72:75], v[136:139], v[96:111]
    ds_read_b64_tr_b16 v[60:61], v10 offset:12352
    ds_read_b64_tr_b16 v[62:63], v10 offset:13120
    v_mfma_f32_32x32x16_bf16 v[112:127], v[76:79], v[136:139], v[112:127]
    ds_read_b64_tr_b16 v[64:65], v10 offset:12416
    ds_read_b64_tr_b16 v[66:67], v10 offset:13184
    s_waitcnt lgkmcnt(6)
    v_mfma_f32_32x32x16_bf16 v[80:95], v[44:47], v[140:143], v[80:95]
    ds_read_b64_tr_b16 v[68:69], v10 offset:15360
    ds_read_b64_tr_b16 v[70:71], v10 offset:16128
    v_mfma_f32_32x32x16_bf16 v[96:111], v[48:51], v[140:143], v[96:111]
    ds_read_b64_tr_b16 v[72:73], v10 offset:15424
    ds_read_b64_tr_b16 v[74:75], v10 offset:16192
    v_mfma_f32_32x32x16_bf16 v[112:127], v[52:55], v[140:143], v[112:127]
    ds_read_b64_tr_b16 v[76:77], v10 offset:15488
    ds_read_b64_tr_b16 v[78:79], v10 offset:16256
    s_waitcnt lgkmcnt(6)
    v_mfma_f32_32x32x16_bf16 v[80:95], v[56:59], v[144:147], v[80:95]
    ds_read_b64_tr_b16 v[44:45], v10 offset:18432
    ds_read_b64_tr_b16 v[46:47], v10 offset:19200
    v_mfma_f32_32x32x16_bf16 v[96:111], v[60:63], v[144:147], v[96:111]
    ds_read_b64_tr_b16 v[48:49], v10 offset:18496
    ds_read_b64_tr_b16 v[50:51], v10 offset:19264
    v_mfma_f32_32x32x16_bf16 v[112:127], v[64:67], v[144:147], v[112:127]
    ds_read_b64_tr_b16 v[52:53], v10 offset:18560
    ds_read_b64_tr_b16 v[54:55], v10 offset:19328
    s_waitcnt lgkmcnt(6)
    v_mfma_f32_32x32x16_bf16 v[80:95], v[68:71], v[148:151], v[80:95]
    ds_read_b64_tr_b16 v[56:57], v10 offset:21504
    ds_read_b64_tr_b16 v[58:59], v10 offset:22272
    v_mfma_f32_32x32x16_bf16 v[96:111], v[72:75], v[148:151], v[96:111]
    ds_read_b64_tr_b16 v[60:61], v10 offset:21568
    ds_read_b64_tr_b16 v[62:63], v10 offset:22336
    v_mfma_f32_32x32x16_bf16 v[112:127], v[76:79], v[148:151], v[112:127]
    ds_read_b64_tr_b16 v[64:65], v10 offset:21632
    ds_read_b64_tr_b16 v[66:67], v10 offset:22400
    s_cmp_eq_u32 s81, 0
    s_cbranch_scc0 L_pc_16
    s_waitcnt vmcnt(0)
    v_mov_b32 v2, 1
    v_mov_b32 v3, 0
    s_mov_b64 exec, 1
    buffer_store_dword v2, v3, s[16:19], s78 offen sc1
    s_mov_b64 exec, -1
    s_mov_b32 s81, 1
L_pc_16:
    s_barrier
    s_waitcnt lgkmcnt(6)
    v_mfma_f32_32x32x16_bf16 v[80:95], v[44:47], v[152:155], v[80:95]
    ds_read_b64_tr_b16 v[68:69], v10 offset:24576
    ds_read_b64_tr_b16 v[70:71], v10 offset:25344
    v_mfma_f32_32x32x16_bf16 v[96:111], v[48:51], v[152:155], v[96:111]
    ds_read_b64_tr_b16 v[72:73], v10 offset:24640
    ds_read_b64_tr_b16 v[74:75], v10 offset:25408
    v_mfma_f32_32x32x16_bf16 v[112:127], v[52:55], v[152:155], v[112:127]
    ds_read_b64_tr_b16 v[76:77], v10 offset:24704
    ds_read_b64_tr_b16 v[78:79], v10 offset:25472
    s_waitcnt lgkmcnt(6)
    v_mfma_f32_32x32x16_bf16 v[80:95], v[56:59], v[156:159], v[80:95]
    ds_read_b64_tr_b16 v[44:45], v10 offset:27648
    ds_read_b64_tr_b16 v[46:47], v10 offset:28416
    v_mfma_f32_32x32x16_bf16 v[96:111], v[60:63], v[156:159], v[96:111]
    ds_read_b64_tr_b16 v[48:49], v10 offset:27712
    ds_read_b64_tr_b16 v[50:51], v10 offset:28480
    v_mfma_f32_32x32x16_bf16 v[112:127], v[64:67], v[156:159], v[112:127]
    ds_read_b64_tr_b16 v[52:53], v10 offset:27776
    ds_read_b64_tr_b16 v[54:55], v10 offset:28544
    s_waitcnt lgkmcnt(6)
    v_mfma_f32_32x32x16_bf16 v[80:95], v[68:71], v[160:163], v[80:95]
    ds_read_b64_tr_b16 v[56:57], v10 offset:30720
    ds_read_b64_tr_b16 v[58:59], v10 offset:31488
    v_mfma_f32_32x32x16_bf16 v[96:111], v[72:75], v[160:163], v[96:111]
    ds_read_b64_tr_b16 v[60:61], v10 offset:30784
    ds_read_b64_tr_b16 v[62:63], v10 offset:31552
    v_mfma_f32_32x32x16_bf16 v[112:127], v[76:79], v[160:163], v[112:127]
    ds_read_b64_tr_b16 v[64:65], v10 offset:30848
    ds_read_b64_tr_b16 v[66:67], v10 offset:31616
    s_waitcnt lgkmcnt(6)
    v_mfma_f32_32x32x16_bf16 v[80:95], v[44:47], v[164:167], v[80:95]
    ds_read_b64_tr_b16 v[68:69], v10 offset:33792
    ds_read_b64_tr_b16 v[70:71], v10 offset:34560
    v_mfma_f32_32x32x16_bf16 v[96:111], v[48:51], v[164:167], v[96:111]
    ds_read_b64_tr_b16 v[72:73], v10 offset:33856
    ds_read_b64_tr_b16 v[74:75], v10 offset:34624
    v_mfma_f32_32x32x16_bf16 v[112:127], v[52:55], v[164:167], v[112:127]
    ds_read_b64_tr_b16 v[76:77], v10 offset:33920
    ds_read_b64_tr_b16 v[78:79], v10 offset:34688
    s_barrier
    s_waitcnt lgkmcnt(6)
    v_mfma_f32_32x32x16_bf16 v[80:95], v[56:59], v[168:171], v[80:95]
    ds_read_b64_tr_b16 v[44:45], v10 offset:36864
    ds_read_b64_tr_b16 v[46:47], v10 offset:37632
    v_mfma_f32_32x32x16_bf16 v[96:111], v[60:63], v[168:171], v[96:111]
    ds_read_b64_tr_b16 v[48:49], v10 offset:36928
    ds_read_b64_tr_b16 v[50:51], v10 offset:37696
    v_mfma_f32_32x32x16_bf16 v[112:127], v[64:67], v[168:171], v[112:127]
    ds_read_b64_tr_b16 v[52:53], v10 offset:36992
    ds_read_b64_tr_b16 v[54:55], v10 offset:37760
    s_waitcnt lgkmcnt(6)
    v_mfma_f32_32x32x16_bf16 v[80:95], v[68:71], v[172:175], v[80:95]
    ds_read_b64_tr_b16 v[56:57], v10 offset:39936
    ds_read_b64_tr_b16 v[58:59], v10 offset:40704
    v_mfma_f32_32x32x16_bf16 v[96:111], v[72:75], v[172:175], v[96:111]
    ds_read_b64_tr_b16 v[60:61], v10 offset:40000
    ds_read_b64_tr_b16 v[62:63], v10 offset:40768
    v_mfma_f32_32x32x16_bf16 v[112:127], v[76:79], v[172:175], v[112:127]
    ds_read_b64_tr_b16 v[64:65], v10 offset:40064
    ds_read_b64_tr_b16 v[66:67], v10 offset:40832
    s_waitcnt lgkmcnt(6)
    v_mfma_f32_32x32x16_bf16 v[80:95], v[44:47], v[176:179], v[80:95]
    ds_read_b64_tr_b16 v[68:69], v10 offset:43008
    ds_read_b64_tr_b16 v[70:71], v10 offset:43776
    v_mfma_f32_32x32x16_bf16 v[96:111], v[48:51], v[176:179], v[96:111]
    ds_read_b64_tr_b16 v[72:73], v10 offset:43072
    ds_read_b64_tr_b16 v[74:75], v10 offset:43840
    v_mfma_f32_32x32x16_bf16 v[112:127], v[52:55], v[176:179], v[112:127]
    ds_read_b64_tr_b16 v[76:77], v10 offset:43136
    ds_read_b64_tr_b16 v[78:79], v10 offset:43904
    s_waitcnt lgkmcnt(6)
    v_mfma_f32_32x32x16_bf16 v[80:95], v[56:59], v[180:183], v[80:95]
    ds_read_b64_tr_b16 v[44:45], v10 offset:46080
    ds_read_b64_tr_b16 v[46:47], v10 offset:46848
    v_mfma_f32_32x32x16_bf16 v[96:111], v[60:63], v[180:183], v[96:111]
    ds_read_b64_tr_b16 v[48:49], v10 offset:46144
    ds_read_b64_tr_b16 v[50:51], v10 offset:46912
    v_mfma_f32_32x32x16_bf16 v[112:127], v[64:67], v[180:183], v[112:127]
    ds_read_b64_tr_b16 v[52:53], v10 offset:46208
    ds_read_b64_tr_b16 v[54:55], v10 offset:46976
    s_waitcnt lgkmcnt(6)
    v_mfma_f32_32x32x16_bf16 v[80:95], v[68:71], v[184:187], v[80:95]
    ds_read_b64_tr_b16 v[56:57], v10 offset:49152
    ds_read_b64_tr_b16 v[58:59], v10 offset:49920
    v_mfma_f32_32x32x16_bf16 v[96:111], v[72:75], v[184:187], v[96:111]
    ds_read_b64_tr_b16 v[60:61], v10 offset:49216
    ds_read_b64_tr_b16 v[62:63], v10 offset:49984
    v_mfma_f32_32x32x16_bf16 v[112:127], v[76:79], v[184:187], v[112:127]
    ds_read_b64_tr_b16 v[64:65], v10 offset:49280
    ds_read_b64_tr_b16 v[66:67], v10 offset:50048
    s_waitcnt lgkmcnt(6)
    v_mfma_f32_32x32x16_bf16 v[80:95], v[44:47], v[188:191], v[80:95]
    ds_read_b64_tr_b16 v[68:69], v10 offset:52224
    ds_read_b64_tr_b16 v[70:71], v10 offset:52992
    v_mfma_f32_32x32x16_bf16 v[96:111], v[48:51], v[188:191], v[96:111]
    ds_read_b64_tr_b16 v[72:73], v10 offset:52288
    ds_read_b64_tr_b16 v[74:75], v10 offset:53056
    v_mfma_f32_32x32x16_bf16 v[112:127], v[52:55], v[188:191], v[112:127]
    ds_read_b64_tr_b16 v[76:77], v10 offset:52352
    ds_read_b64_tr_b16 v[78:79], v10 offset:53120
    s_waitcnt lgkmcnt(6)
    v_mfma_f32_32x32x16_bf16 v[80:95], v[56:59], v[192:195], v[80:95]
    ds_read_b64_tr_b16 v[44:45], v10 offset:55296
    ds_read_b64_tr_b16 v[46:47], v10 offset:56064
    v_mfma_f32_32x32x16_bf16 v[96:111], v[60:63], v[192:195], v[96:111]
    ds_read_b64_tr_b16 v[48:49], v10 offset:55360
    ds_read_b64_tr_b16 v[50:51], v10 offset:56128
    v_mfma_f32_32x32x16_bf16 v[112:127], v[64:67], v[192:195], v[112:127]
    ds_read_b64_tr_b16 v[52:53], v10 offset:55424
    ds_read_b64_tr_b16 v[54:55], v10 offset:56192
    s_waitcnt lgkmcnt(6)
    v_mfma_f32_32x32x16_bf16 v[80:95], v[68:71], v[196:199], v[80:95]
    ds_read_b64_tr_b16 v[56:57], v10 offset:58368
    ds_read_b64_tr_b16 v[58:59], v10 offset:59136
    v_mfma_f32_32x32x16_bf16 v[96:111], v[72:75], v[196:199], v[96:111]
    ds_read_b64_tr_b16 v[60:61], v10 offset:58432
    ds_read_b64_tr_b16 v[62:63], v10 offset:59200
    v_mfma_f32_32x32x16_bf16 v[112:127], v[76:79], v[196:199], v[112:127]
    ds_read_b64_tr_b16 v[64:65], v10 offset:58496
    ds_read_b64_tr_b16 v[66:67], v10 offset:59264
    s_barrier
    s_waitcnt lgkmcnt(6)
    v_mfma_f32_32x32x16_bf16 v[80:95], v[44:47], v[200:203], v[80:95]
    v_add_u32 v10, 0xffff0000, v10
    ds_read_b64_tr_b16 v[68:69], v10 offset:0
    v_mfma_f32_32x32x16_bf16 v[96:111], v[48:51], v[200:203], v[96:111]
    ds_read_b64_tr_b16 v[70:71], v10 offset:768
    ds_read_b64_tr_b16 v[72:73], v10 offset:64
    v_mfma_f32_32x32x16_bf16 v[112:127], v[52:55], v[200:203], v[112:127]
    ds_read_b64_tr_b16 v[74:75], v10 offset:832
    ds_read_b64_tr_b16 v[76:77], v10 offset:128
    ds_read_b64_tr_b16 v[78:79], v10 offset:896
    s_waitcnt lgkmcnt(6)
    v_mfma_f32_32x32x16_bf16 v[80:95], v[56:59], v[204:207], v[80:95]
    ds_read_b64_tr_b16 v[44:45], v10 offset:3072
    ds_read_b64_tr_b16 v[46:47], v10 offset:3840
    v_mfma_f32_32x32x16_bf16 v[96:111], v[60:63], v[204:207], v[96:111]
    ds_read_b64_tr_b16 v[48:49], v10 offset:3136
    ds_read_b64_tr_b16 v[50:51], v10 offset:3904
    v_mfma_f32_32x32x16_bf16 v[112:127], v[64:67], v[204:207], v[112:127]
    ds_read_b64_tr_b16 v[52:53], v10 offset:3200
    ds_read_b64_tr_b16 v[54:55], v10 offset:3968
    s_waitcnt lgkmcnt(6)
    v_mfma_f32_32x32x16_bf16 v[80:95], v[68:71], v[208:211], v[80:95]
    ds_read_b64_tr_b16 v[56:57], v10 offset:6144
    ds_read_b64_tr_b16 v[58:59], v10 offset:6912
    v_mfma_f32_32x32x16_bf16 v[96:111], v[72:75], v[208:211], v[96:111]
    ds_read_b64_tr_b16 v[60:61], v10 offset:6208
    ds_read_b64_tr_b16 v[62:63], v10 offset:6976
    v_mfma_f32_32x32x16_bf16 v[112:127], v[76:79], v[208:211], v[112:127]
    ds_read_b64_tr_b16 v[64:65], v10 offset:6272
    ds_read_b64_tr_b16 v[66:67], v10 offset:7040
    s_waitcnt lgkmcnt(6)
    v_mfma_f32_32x32x16_bf16 v[80:95], v[44:47], v[212:215], v[80:95]
    ds_read_b64_tr_b16 v[68:69], v10 offset:9216
    ds_read_b64_tr_b16 v[70:71], v10 offset:9984
    v_mfma_f32_32x32x16_bf16 v[96:111], v[48:51], v[212:215], v[96:111]
    ds_read_b64_tr_b16 v[72:73], v10 offset:9280
    ds_read_b64_tr_b16 v[74:75], v10 offset:10048
    v_mfma_f32_32x32x16_bf16 v[112:127], v[52:55], v[212:215], v[112:127]
    ds_read_b64_tr_b16 v[76:77], v10 offset:9344
    ds_read_b64_tr_b16 v[78:79], v10 offset:10112
    s_waitcnt lgkmcnt(6)
    v_mfma_f32_32x32x16_bf16 v[80:95], v[56:59], v[216:219], v[80:95]
    ds_read_b64_tr_b16 v[44:45], v10 offset:12288
    ds_read_b64_tr_b16 v[46:47], v10 offset:13056
    v_mfma_f32_32x32x16_bf16 v[96:111], v[60:63], v[216:219], v[96:111]
    ds_read_b64_tr_b16 v[48:49], v10 offset:12352
    ds_read_b64_tr_b16 v[50:51], v10 offset:13120
    v_mfma_f32_32x32x16_bf16 v[112:127], v[64:67], v[216:219], v[112:127]
    ds_read_b64_tr_b16 v[52:53], v10 offset:12416
    ds_read_b64_tr_b16 v[54:55], v10 offset:13184
    s_waitcnt lgkmcnt(6)
    v_mfma_f32_32x32x16_bf16 v[80:95], v[68:71], v[220:223], v[80:95]
    ds_read_b64_tr_b16 v[56:57], v10 offset:15360
    ds_read_b64_tr_b16 v[58:59], v10 offset:16128
    v_mfma_f32_32x32x16_bf16 v[96:111], v[72:75], v[220:223], v[96:111]
    ds_read_b64_tr_b16 v[60:61], v10 offset:15424
    ds_read_b64_tr_b16 v[62:63], v10 offset:16192
    v_mfma_f32_32x32x16_bf16 v[112:127], v[76:79], v[220:223], v[112:127]
    ds_read_b64_tr_b16 v[64:65], v10 offset:15488
    ds_read_b64_tr_b16 v[66:67], v10 offset:16256
    s_waitcnt lgkmcnt(6)
    v_mfma_f32_32x32x16_bf16 v[80:95], v[44:47], v[224:227], v[80:95]
    ds_read_b64_tr_b16 v[68:69], v10 offset:18432
    ds_read_b64_tr_b16 v[70:71], v10 offset:19200
    v_mfma_f32_32x32x16_bf16 v[96:111], v[48:51], v[224:227], v[96:111]
    ds_read_b64_tr_b16 v[72:73], v10 offset:18496
    ds_read_b64_tr_b16 v[74:75], v10 offset:19264
    v_mfma_f32_32x32x16_bf16 v[112:127], v[52:55], v[224:227], v[112:127]
    ds_read_b64_tr_b16 v[76:77], v10 offset:18560
    ds_read_b64_tr_b16 v[78:79], v10 offset:19328
    s_waitcnt lgkmcnt(6)
    v_mfma_f32_32x32x16_bf16 v[80:95], v[56:59], v[228:231], v[80:95]
    ds_read_b64_tr_b16 v[44:45], v10 offset:21504
    ds_read_b64_tr_b16 v[46:47], v10 offset:22272
    v_mfma_f32_32x32x16_bf16 v[96:111], v[60:63], v[228:231], v[96:111]
    ds_read_b64_tr_b16 v[48:49], v10 offset:21568
    ds_read_b64_tr_b16 v[50:51], v10 offset:22336
    v_mfma_f32_32x32x16_bf16 v[112:127], v[64:67], v[228:231], v[112:127]
    ds_read_b64_tr_b16 v[52:53], v10 offset:21632
    ds_read_b64_tr_b16 v[54:55], v10 offset:22400
    s_waitcnt lgkmcnt(6)
    v_mfma_f32_32x32x16_bf16 v[80:95], v[68:71], v[232:235], v[80:95]
    ds_read_b64_tr_b16 v[56:57], v10 offset:24576
    ds_read_b64_tr_b16 v[58:59], v10 offset:25344
    v_mfma_f32_32x32x16_bf16 v[96:111], v[72:75], v[232:235], v[96:111]
    ds_read_b64_tr_b16 v[60:61], v10 offset:24640
    ds_read_b64_tr_b16 v[62:63], v10 offset:25408
    v_mfma_f32_32x32x16_bf16 v[112:127], v[76:79], v[232:235], v[112:127]
    ds_read_b64_tr_b16 v[64:65], v10 offset:24704
    ds_read_b64_tr_b16 v[66:67], v10 offset:25472
    s_waitcnt lgkmcnt(6)
    v_mfma_f32_32x32x16_bf16 v[80:95], v[44:47], v[236:239], v[80:95]
    ds_read_b64_tr_b16 v[68:69], v10 offset:27648
    ds_read_b64_tr_b16 v[70:71], v10 offset:28416
    v_mfma_f32_32x32x16_bf16 v[96:111], v[48:51], v[236:239], v[96:111]
    ds_read_b64_tr_b16 v[72:73], v10 offset:27712
    ds_read_b64_tr_b16 v[74:75], v10 offset:28480
    v_mfma_f32_32x32x16_bf16 v[112:127], v[52:55], v[236:239], v[112:127]
    ds_read_b64_tr_b16 v[76:77], v10 offset:27776
    ds_read_b64_tr_b16 v[78:79], v10 offset:28544
    s_waitcnt lgkmcnt(6)
    v_mfma_f32_32x32x16_bf16 v[80:95], v[56:59], v[240:243], v[80:95]
    ds_read_b64_tr_b16 v[44:45], v10 offset:30720
    ds_read_b64_tr_b16 v[46:47], v10 offset:31488
    v_mfma_f32_32x32x16_bf16 v[96:111], v[60:63], v[240:243], v[96:111]
    ds_read_b64_tr_b16 v[48:49], v10 offset:30784
    ds_read_b64_tr_b16 v[50:51], v10 offset:31552
    v_mfma_f32_32x32x16_bf16 v[112:127], v[64:67], v[240:243], v[112:127]
    ds_read_b64_tr_b16 v[52:53], v10 offset:30848
    ds_read_b64_tr_b16 v[54:55], v10 offset:31616
    s_waitcnt lgkmcnt(6)
    v_mfma_f32_32x32x16_bf16 v[80:95], v[68:71], v[244:247], v[80:95]
    ds_read_b64_tr_b16 v[56:57], v10 offset:33792
    ds_read_b64_tr_b16 v[58:59], v10 offset:34560
    v_mfma_f32_32x32x16_bf16 v[96:111], v[72:75], v[244:247], v[96:111]
    ds_read_b64_tr_b16 v[60:61], v10 offset:33856
    ds_read_b64_tr_b16 v[62:63], v10 offset:34624
    v_mfma_f32_32x32x16_bf16 v[112:127], v[76:79], v[244:247], v[112:127]
    ds_read_b64_tr_b16 v[64:65], v10 offset:33920
    ds_read_b64_tr_b16 v[66:67], v10 offset:34688
    s_waitcnt lgkmcnt(6)
    v_mfma_f32_32x32x16_bf16 v[80:95], v[44:47], v[248:251], v[80:95]
    v_mfma_f32_32x32x16_bf16 v[96:111], v[48:51], v[248:251], v[96:111]
    v_mfma_f32_32x32x16_bf16 v[112:127], v[52:55], v[248:251], v[112:127]
    s_waitcnt lgkmcnt(0)
    v_mfma_f32_32x32x16_bf16 v[80:95], v[56:59], v[252:255], v[80:95]
    v_mfma_f32_32x32x16_bf16 v[96:111], v[60:63], v[252:255], v[96:111]
    v_mfma_f32_32x32x16_bf16 v[112:127], v[64:67], v[252:255], v[112:127]
    v_mov_b32 v2, 150528
L_afw_17:
    ds_read_b32 v3, v2
    ds_read_b128 v[44:47], v14 offset:1536
    ds_read_b128 v[48:51], v14 offset:2048
    ds_read_b128 v[52:55], v14 offset:2560
    s_waitcnt lgkmcnt(0)
    v_readfirstlane_b32 s64, v3
    s_cmp_eq_u32 s64, 3
    s_cbranch_scc0 L_afw_17
    v_mfma_f32_32x32x16_bf16 v[80:95], v[44:47], v[36:39], v[80:95]
    v_mfma_f32_32x32x16_bf16 v[96:111], v[48:51], v[36:39], v[96:111]
    v_mfma_f32_32x32x16_bf16 v[112:127], v[52:55], v[36:39], v[112:127]
    v_mul_f32 v20, 0xc0135761, v18
    v_mul_f32 v2, v18, v18
    v_mul_f32 v21, 0x3d372713, v20
    v_mul_f32 v21, v21, v2
    s_mov_b32 s3, s80
    s_nop 5
    v_pk_mul_f32 v[56:57], v[80:81], v[80:81]
    v_pk_mul_f32 v[58:59], v[82:83], v[82:83]
    v_pk_mul_f32 v[60:61], v[84:85], v[84:85]
    v_pk_mul_f32 v[62:63], v[86:87], v[86:87]
    v_pk_mul_f32 v[64:65], v[88:89], v[88:89]
    v_pk_mul_f32 v[66:67], v[90:91], v[90:91]
    v_pk_mul_f32 v[68:69], v[92:93], v[92:93]
    v_pk_mul_f32 v[70:71], v[94:95], v[94:95]
    v_pk_fma_f32 v[56:57], v[56:57], v[20:21], v[20:21] op_sel:[0,1,0] op_sel_hi:[1,1,0]
    v_pk_fma_f32 v[58:59], v[58:59], v[20:21], v[20:21] op_sel:[0,1,0] op_sel_hi:[1,1,0]
    v_pk_fma_f32 v[60:61], v[60:61], v[20:21], v[20:21] op_sel:[0,1,0] op_sel_hi:[1,1,0]
    v_pk_fma_f32 v[62:63], v[62:63], v[20:21], v[20:21] op_sel:[0,1,0] op_sel_hi:[1,1,0]
    v_pk_fma_f32 v[64:65], v[64:65], v[20:21], v[20:21] op_sel:[0,1,0] op_sel_hi:[1,1,0]
    v_pk_fma_f32 v[66:67], v[66:67], v[20:21], v[20:21] op_sel:[0,1,0] op_sel_hi:[1,1,0]
    v_pk_fma_f32 v[68:69], v[68:69], v[20:21], v[20:21] op_sel:[0,1,0] op_sel_hi:[1,1,0]
    v_pk_fma_f32 v[70:71], v[70:71], v[20:21], v[20:21] op_sel:[0,1,0] op_sel_hi:[1,1,0]
    v_pk_mul_f32 v[56:57], v[56:57], v[80:81]
    v_pk_mul_f32 v[58:59], v[58:59], v[82:83]
    v_pk_mul_f32 v[60:61], v[60:61], v[84:85]
    v_pk_mul_f32 v[62:63], v[62:63], v[86:87]
    v_pk_mul_f32 v[64:65], v[64:65], v[88:89]
    v_pk_mul_f32 v[66:67], v[66:67], v[90:91]
    v_pk_mul_f32 v[68:69], v[68:69], v[92:93]
    v_pk_mul_f32 v[70:71], v[70:71], v[94:95]
    v_exp_f32 v56, v56
    v_exp_f32 v57, v57
    v_exp_f32 v58, v58
    v_exp_f32 v59, v59
    v_exp_f32 v60, v60
    v_exp_f32 v61, v61
    v_exp_f32 v62, v62
    v_exp_f32 v63, v63
    v_exp_f32 v64, v64
    v_exp_f32 v65, v65
    v_exp_f32 v66, v66
    v_exp_f32 v67, v67
    v_exp_f32 v68, v68
    v_exp_f32 v69, v69
    v_exp_f32 v70, v70
    v_exp_f32 v71, v71
    v_pk_fma_f32 v[56:57], v[56:57], v[18:19], v[18:19] op_sel:[0,1,1] op_sel_hi:[1,1,1]
    v_pk_fma_f32 v[58:59], v[58:59], v[18:19], v[18:19] op_sel:[0,1,1] op_sel_hi:[1,1,1]
    v_pk_fma_f32 v[60:61], v[60:61], v[18:19], v[18:19] op_sel:[0,1,1] op_sel_hi:[1,1,1]
    v_pk_fma_f32 v[62:63], v[62:63], v[18:19], v[18:19] op_sel:[0,1,1] op_sel_hi:[1,1,1]
    v_pk_fma_f32 v[64:65], v[64:65], v[18:19], v[18:19] op_sel:[0,1,1] op_sel_hi:[1,1,1]
    v_pk_fma_f32 v[66:67], v[66:67], v[18:19], v[18:19] op_sel:[0,1,1] op_sel_hi:[1,1,1]
    v_pk_fma_f32 v[68:69], v[68:69], v[18:19], v[18:19] op_sel:[0,1,1] op_sel_hi:[1,1,1]
    v_pk_fma_f32 v[70:71], v[70:71], v[18:19], v[18:19] op_sel:[0,1,1] op_sel_hi:[1,1,1]
    v_rcp_f32 v56, v56
    v_rcp_f32 v57, v57
    v_rcp_f32 v58, v58
    v_rcp_f32 v59, v59
    v_rcp_f32 v60, v60
    v_rcp_f32 v61, v61
    v_rcp_f32 v62, v62
    v_rcp_f32 v63, v63
    v_rcp_f32 v64, v64
    v_rcp_f32 v65, v65
    v_rcp_f32 v66, v66
    v_rcp_f32 v67, v67
    v_rcp_f32 v68, v68
    v_rcp_f32 v69, v69
    v_rcp_f32 v70, v70
    v_rcp_f32 v71, v71
    v_pk_mul_f32 v[80:81], v[80:81], v[56:57]
    v_pk_mul_f32 v[82:83], v[82:83], v[58:59]
    v_pk_mul_f32 v[84:85], v[84:85], v[60:61]
    v_pk_mul_f32 v[86:87], v[86:87], v[62:63]
    v_pk_mul_f32 v[88:89], v[88:89], v[64:65]
    v_pk_mul_f32 v[90:91], v[90:91], v[66:67]
    v_pk_mul_f32 v[92:93], v[92:93], v[68:69]
    v_pk_mul_f32 v[94:95], v[94:95], v[70:71]
    v_cvt_pk_bf16_f32 v80, v80, v81
    v_cvt_pk_bf16_f32 v81, v82, v83
    v_cvt_pk_bf16_f32 v82, v84, v85
    v_cvt_pk_bf16_f32 v83, v86, v87
    v_cvt_pk_bf16_f32 v84, v88, v89
    v_cvt_pk_bf16_f32 v85, v90, v91
    v_cvt_pk_bf16_f32 v86, v92, v93
    v_cvt_pk_bf16_f32 v87, v94, v95
    buffer_store_dwordx4 v[80:83], v11, s[16:19], s79 offen offset:0 sc1
    buffer_store_dwordx4 v[84:87], v11, s[16:19], s79 offen offset:1024 sc1
    v_pk_mul_f32 v[56:57], v[96:97], v[96:97]
    v_pk_mul_f32 v[58:59], v[98:99], v[98:99]
    v_pk_mul_f32 v[60:61], v[100:101], v[100:101]
    v_pk_mul_f32 v[62:63], v[102:103], v[102:103]
    v_pk_mul_f32 v[64:65], v[104:105], v[104:105]
    v_pk_mul_f32 v[66:67], v[106:107], v[106:107]
    v_pk_mul_f32 v[68:69], v[108:109], v[108:109]
    v_pk_mul_f32 v[70:71], v[110:111], v[110:111]
    v_pk_fma_f32 v[56:57], v[56:57], v[20:21], v[20:21] op_sel:[0,1,0] op_sel_hi:[1,1,0]
    v_pk_fma_f32 v[58:59], v[58:59], v[20:21], v[20:21] op_sel:[0,1,0] op_sel_hi:[1,1,0]
    v_pk_fma_f32 v[60:61], v[60:61], v[20:21], v[20:21] op_sel:[0,1,0] op_sel_hi:[1,1,0]
    v_pk_fma_f32 v[62:63], v[62:63], v[20:21], v[20:21] op_sel:[0,1,0] op_sel_hi:[1,1,0]
    v_pk_fma_f32 v[64:65], v[64:65], v[20:21], v[20:21] op_sel:[0,1,0] op_sel_hi:[1,1,0]
    v_pk_fma_f32 v[66:67], v[66:67], v[20:21], v[20:21] op_sel:[0,1,0] op_sel_hi:[1,1,0]
    v_pk_fma_f32 v[68:69], v[68:69], v[20:21], v[20:21] op_sel:[0,1,0] op_sel_hi:[1,1,0]
    v_pk_fma_f32 v[70:71], v[70:71], v[20:21], v[20:21] op_sel:[0,1,0] op_sel_hi:[1,1,0]
    v_pk_mul_f32 v[56:57], v[56:57], v[96:97]
    v_pk_mul_f32 v[58:59], v[58:59], v[98:99]
    v_pk_mul_f32 v[60:61], v[60:61], v[100:101]
    v_pk_mul_f32 v[62:63], v[62:63], v[102:103]
    v_pk_mul_f32 v[64:65], v[64:65], v[104:105]
    v_pk_mul_f32 v[66:67], v[66:67], v[106:107]
    v_pk_mul_f32 v[68:69], v[68:69], v[108:109]
    v_pk_mul_f32 v[70:71], v[70:71], v[110:111]
    v_exp_f32 v56, v56
    v_exp_f32 v57, v57
    v_exp_f32 v58, v58
    v_exp_f32 v59, v59
    v_exp_f32 v60, v60
    v_exp_f32 v61, v61
    v_exp_f32 v62, v62
    v_exp_f32 v63, v63
    v_exp_f32 v64, v64
    v_exp_f32 v65, v65
    v_exp_f32 v66, v66
    v_exp_f32 v67, v67
    v_exp_f32 v68, v68
    v_exp_f32 v69, v69
    v_exp_f32 v70, v70
    v_exp_f32 v71, v71
    v_pk_fma_f32 v[56:57], v[56:57], v[18:19], v[18:19] op_sel:[0,1,1] op_sel_hi:[1,1,1]
    v_pk_fma_f32 v[58:59], v[58:59], v[18:19], v[18:19] op_sel:[0,1,1] op_sel_hi:[1,1,1]
    v_pk_fma_f32 v[60:61], v[60:61], v[18:19], v[18:19] op_sel:[0,1,1] op_sel_hi:[1,1,1]
    v_pk_fma_f32 v[62:63], v[62:63], v[18:19], v[18:19] op_sel:[0,1,1] op_sel_hi:[1,1,1]
    v_pk_fma_f32 v[64:65], v[64:65], v[18:19], v[18:19] op_sel:[0,1,1] op_sel_hi:[1,1,1]
    v_pk_fma_f32 v[66:67], v[66:67], v[18:19], v[18:19] op_sel:[0,1,1] op_sel_hi:[1,1,1]
    v_pk_fma_f32 v[68:69], v[68:69], v[18:19], v[18:19] op_sel:[0,1,1] op_sel_hi:[1,1,1]
    v_pk_fma_f32 v[70:71], v[70:71], v[18:19], v[18:19] op_sel:[0,1,1] op_sel_hi:[1,1,1]
    v_rcp_f32 v56, v56
    v_rcp_f32 v57, v57
    v_rcp_f32 v58, v58
    v_rcp_f32 v59, v59
    v_rcp_f32 v60, v60
    v_rcp_f32 v61, v61
    v_rcp_f32 v62, v62
    v_rcp_f32 v63, v63
    v_rcp_f32 v64, v64
    v_rcp_f32 v65, v65
    v_rcp_f32 v66, v66
    v_rcp_f32 v67, v67
    v_rcp_f32 v68, v68
    v_rcp_f32 v69, v69
    v_rcp_f32 v70, v70
    v_rcp_f32 v71, v71
    v_pk_mul_f32 v[96:97], v[96:97], v[56:57]
    v_pk_mul_f32 v[98:99], v[98:99], v[58:59]
    v_pk_mul_f32 v[100:101], v[100:101], v[60:61]
    v_pk_mul_f32 v[102:103], v[102:103], v[62:63]
    v_pk_mul_f32 v[104:105], v[104:105], v[64:65]
    v_pk_mul_f32 v[106:107], v[106:107], v[66:67]
    v_pk_mul_f32 v[108:109], v[108:109], v[68:69]
    v_pk_mul_f32 v[110:111], v[110:111], v[70:71]
    v_cvt_pk_bf16_f32 v96, v96, v97
    v_cvt_pk_bf16_f32 v97, v98, v99
    v_cvt_pk_bf16_f32 v98, v100, v101
    v_cvt_pk_bf16_f32 v99, v102, v103
    v_cvt_pk_bf16_f32 v100, v104, v105
    v_cvt_pk_bf16_f32 v101, v106, v107
    v_cvt_pk_bf16_f32 v102, v108, v109
    v_cvt_pk_bf16_f32 v103, v110, v111
    buffer_store_dwordx4 v[96:99], v11, s[16:19], s79 offen offset:2048 sc1
    buffer_store_dwordx4 v[100:103], v11, s[16:19], s79 offen offset:3072 sc1
    s_cmp_ge_u32 s71, 33
    s_cbranch_scc1 L_p2c
    v_pk_mul_f32 v[56:57], v[112:113], v[112:113]
    v_pk_mul_f32 v[58:59], v[114:115], v[114:115]
    v_pk_mul_f32 v[60:61], v[116:117], v[116:117]
    v_pk_mul_f32 v[62:63], v[118:119], v[118:119]
    v_pk_mul_f32 v[64:65], v[120:121], v[120:121]
    v_pk_mul_f32 v[66:67], v[122:123], v[122:123]
    v_pk_mul_f32 v[68:69], v[124:125], v[124:125]
    v_pk_mul_f32 v[70:71], v[126:127], v[126:127]
    v_pk_fma_f32 v[56:57], v[56:57], v[20:21], v[20:21] op_sel:[0,1,0] op_sel_hi:[1,1,0]
    v_pk_fma_f32 v[58:59], v[58:59], v[20:21], v[20:21] op_sel:[0,1,0] op_sel_hi:[1,1,0]
    v_pk_fma_f32 v[60:61], v[60:61], v[20:21], v[20:21] op_sel:[0,1,0] op_sel_hi:[1,1,0]
    v_pk_fma_f32 v[62:63], v[62:63], v[20:21], v[20:21] op_sel:[0,1,0] op_sel_hi:[1,1,0]
    v_pk_fma_f32 v[64:65], v[64:65], v[20:21], v[20:21] op_sel:[0,1,0] op_sel_hi:[1,1,0]
    v_pk_fma_f32 v[66:67], v[66:67], v[20:21], v[20:21] op_sel:[0,1,0] op_sel_hi:[1,1,0]
    v_pk_fma_f32 v[68:69], v[68:69], v[20:21], v[20:21] op_sel:[0,1,0] op_sel_hi:[1,1,0]
    v_pk_fma_f32 v[70:71], v[70:71], v[20:21], v[20:21] op_sel:[0,1,0] op_sel_hi:[1,1,0]
    v_pk_mul_f32 v[56:57], v[56:57], v[112:113]
    v_pk_mul_f32 v[58:59], v[58:59], v[114:115]
    v_pk_mul_f32 v[60:61], v[60:61], v[116:117]
    v_pk_mul_f32 v[62:63], v[62:63], v[118:119]
    v_pk_mul_f32 v[64:65], v[64:65], v[120:121]
    v_pk_mul_f32 v[66:67], v[66:67], v[122:123]
    v_pk_mul_f32 v[68:69], v[68:69], v[124:125]
    v_pk_mul_f32 v[70:71], v[70:71], v[126:127]
    v_exp_f32 v56, v56
    v_exp_f32 v57, v57
    v_exp_f32 v58, v58
    v_exp_f32 v59, v59
    v_exp_f32 v60, v60
    v_exp_f32 v61, v61
    v_exp_f32 v62, v62
    v_exp_f32 v63, v63
    v_exp_f32 v64, v64
    v_exp_f32 v65, v65
    v_exp_f32 v66, v66
    v_exp_f32 v67, v67
    v_exp_f32 v68, v68
    v_exp_f32 v69, v69
    v_exp_f32 v70, v70
    v_exp_f32 v71, v71
    v_pk_fma_f32 v[56:57], v[56:57], v[18:19], v[18:19] op_sel:[0,1,1] op_sel_hi:[1,1,1]
    v_pk_fma_f32 v[58:59], v[58:59], v[18:19], v[18:19] op_sel:[0,1,1] op_sel_hi:[1,1,1]
    v_pk_fma_f32 v[60:61], v[60:61], v[18:19], v[18:19] op_sel:[0,1,1] op_sel_hi:[1,1,1]
    v_pk_fma_f32 v[62:63], v[62:63], v[18:19], v[18:19] op_sel:[0,1,1] op_sel_hi:[1,1,1]
    v_pk_fma_f32 v[64:65], v[64:65], v[18:19], v[18:19] op_sel:[0,1,1] op_sel_hi:[1,1,1]
    v_pk_fma_f32 v[66:67], v[66:67], v[18:19], v[18:19] op_sel:[0,1,1] op_sel_hi:[1,1,1]
    v_pk_fma_f32 v[68:69], v[68:69], v[18:19], v[18:19] op_sel:[0,1,1] op_sel_hi:[1,1,1]
    v_pk_fma_f32 v[70:71], v[70:71], v[18:19], v[18:19] op_sel:[0,1,1] op_sel_hi:[1,1,1]
    v_rcp_f32 v56, v56
    v_rcp_f32 v57, v57
    v_rcp_f32 v58, v58
    v_rcp_f32 v59, v59
    v_rcp_f32 v60, v60
    v_rcp_f32 v61, v61
    v_rcp_f32 v62, v62
    v_rcp_f32 v63, v63
    v_rcp_f32 v64, v64
    v_rcp_f32 v65, v65
    v_rcp_f32 v66, v66
    v_rcp_f32 v67, v67
    v_rcp_f32 v68, v68
    v_rcp_f32 v69, v69
    v_rcp_f32 v70, v70
    v_rcp_f32 v71, v71
    v_pk_mul_f32 v[112:113], v[112:113], v[56:57]
    v_pk_mul_f32 v[114:115], v[114:115], v[58:59]
    v_pk_mul_f32 v[116:117], v[116:117], v[60:61]
    v_pk_mul_f32 v[118:119], v[118:119], v[62:63]
    v_pk_mul_f32 v[120:121], v[120:121], v[64:65]
    v_pk_mul_f32 v[122:123], v[122:123], v[66:67]
    v_pk_mul_f32 v[124:125], v[124:125], v[68:69]
    v_pk_mul_f32 v[126:127], v[126:127], v[70:71]
    v_cvt_pk_bf16_f32 v112, v112, v113
    v_cvt_pk_bf16_f32 v113, v114, v115
    v_cvt_pk_bf16_f32 v114, v116, v117
    v_cvt_pk_bf16_f32 v115, v118, v119
    v_cvt_pk_bf16_f32 v116, v120, v121
    v_cvt_pk_bf16_f32 v117, v122, v123
    v_cvt_pk_bf16_f32 v118, v124, v125
    v_cvt_pk_bf16_f32 v119, v126, v127
    s_add_u32 s79, s79, 4096
    buffer_store_dwordx4 v[112:115], v11, s[16:19], s79 offen offset:0 sc1
    buffer_store_dwordx4 v[116:119], v11, s[16:19], s79 offen offset:1024 sc1
    s_branch L_p2c
L_p2h:
    v_mov_b32 v7, 150532
    s_cmp_eq_u32 s58, 7
    s_cbranch_scc0 L_fin_18_l
L_fin_18:
    buffer_load_dword v10, v8, s[16:19], s81 offen sc1
    buffer_load_dword v11, v8, s[16:19], s82 offen sc1
    buffer_load_dword v12, v9, s[16:19], s83 offen sc1
    s_waitcnt vmcnt(0)
    v_and_b32 v10, v10, v11
    v_and_b32 v10, v10, v12
    v_cmp_eq_u32 vcc, 1, v10
    s_cmp_eq_u64 vcc, exec
    s_cbranch_scc1 L_fin_18_ok
    s_sleep 1
    s_branch L_fin_18
L_fin_18_ok:
    ds_write_b32 v7, v10
    s_branch L_fin_18_go
L_fin_18_l:
    ds_read_b32 v10, v7
    s_waitcnt lgkmcnt(0)
    v_readfirstlane_b32 s64, v10
    s_cmp_eq_u32 s64, 0
    s_cbranch_scc0 L_fin_18_go
    s_sleep 1
    s_branch L_fin_18_l
L_fin_18_go:
    s_lshl_b32 s64, s59, 6
    s_lshl_b32 s65, s60, 3
    s_add_u32 s64, s64, s65
    s_lshl_b32 s65, s61, 1
    s_add_u32 s64, s64, s65
    s_lshl_b32 s64, s64, 10
    s_lshl_b32 s65, s61, 11
    s_add_u32 m0, s65, 155648
    s_lshl_b32 s66, s61, 10
    buffer_load_dwordx4 v6, s[16:19], s64 offen sc1 lds
    buffer_load_dwordx4 v6, s[16:19], s64 offen offset:1024 sc1 lds
    s_lshl_b32 s67, s59, 17
    s_add_u32 s67, s67, s66
    s_add_u32 s67, s67, 2097152
    s_add_u32 m0, s66, 0
    s_add_u32 s64, s67, 0
    buffer_load_dwordx4 v6, s[16:19], s64 offen sc1 lds
    s_add_u32 m0, s66, 65536
    s_add_u32 s64, s67, 65536
    buffer_load_dwordx4 v6, s[16:19], s64 offen sc1 lds
    s_add_u32 m0, s66, 4096
    s_add_u32 s64, s67, 4096
    buffer_load_dwordx4 v6, s[16:19], s64 offen sc1 lds
    s_add_u32 m0, s66, 69632
    s_add_u32 s64, s67, 69632
    buffer_load_dwordx4 v6, s[16:19], s64 offen sc1 lds
    s_add_u32 m0, s66, 8192
    s_add_u32 s64, s67, 8192
    buffer_load_dwordx4 v6, s[16:19], s64 offen sc1 lds
    s_add_u32 m0, s66, 73728
    s_add_u32 s64, s67, 73728
    buffer_load_dwordx4 v6, s[16:19], s64 offen sc1 lds
    s_add_u32 m0, s66, 12288
    s_add_u32 s64, s67, 12288
    buffer_load_dwordx4 v6, s[16:19], s64 offen sc1 lds
    s_add_u32 m0, s66, 77824
    s_add_u32 s64, s67, 77824
    buffer_load_dwordx4 v6, s[16:19], s64 offen sc1 lds
    s_add_u32 m0, s66, 16384
    s_add_u32 s64, s67, 16384
    buffer_load_dwordx4 v6, s[16:19], s64 offen sc1 lds
    s_add_u32 m0, s66, 81920
    s_add_u32 s64, s67, 81920
    buffer_load_dwordx4 v6, s[16:19], s64 offen sc1 lds
    s_mov_b32 s3, 0
    s_branch L_p2com_19
L_p2c:
    s_and_b32 s64, s2, 7
    s_lshl_b32 s64, s64, 2
    s_bfe_u32 s65, s2, 0x20003
    s_add_u32 s59, s64, s65
    s_lshr_b32 s60, s2, 5
    s_and_b32 s61, s58, 3
    s_lshr_b32 s62, s58, 2
    v_lshlrev_b32 v6, 4, v1
L_p2com_19:
    s_lshl_b32 s64, s62, 16
    v_and_b32 v2, 27, v1
    v_mov_b32 v3, 0x3f803f80
    v_cmp_eq_u32 vcc, 16, v2
    v_add_u32 v8, s64, v6
    v_lshrrev_b32 v4, 5, v1
    v_cndmask_b32 v2, 0, v3, vcc
    v_lshlrev_b32 v4, 8, v4
    v_and_b32 v3, 15, v1
    v_lshlrev_b32 v3, 4, v3
    v_add3_u32 v9, v4, v3, s64
    s_mov_b32 s74, 0x0000ffff
    s_mov_b32 s75, 0x0000ffff
    s_lshl_b32 s65, s61, 11
    s_add_u32 s65, s65, 155648
    v_add_u32 v4, s65, v6
    v_mov_b32 v148, v2
    v_mov_b32 v149, v2
    v_mov_b32 v150, v2
    v_mov_b32 v151, v2
    v_mov_b32 v152, v2
    v_mov_b32 v153, v2
    v_mov_b32 v154, v2
    v_mov_b32 v155, v2
    s_cmp_lt_u32 s58, 4
    s_cbranch_scc1 L_barA_20
    s_waitcnt vmcnt(0)
L_barA_20:
    s_waitcnt lgkmcnt(0)
    s_barrier
    ds_read_b128 v[132:135], v4
    ds_read_b128 v[140:143], v8 offset:0
    ds_read_b128 v[136:139], v4 offset:1024
    s_mov_b64 exec, s[74:75]
    ds_read_b128 v[148:151], v9 offset:1024
    ds_read_b128 v[152:155], v9 offset:1536
    s_mov_b64 exec, -1
    ds_read_b128 v[144:147], v8 offset:2048
    s_setprio 3
    v_mov_b32 v7, 0xdddddddd
    v_mov_b32 v156, v2
    v_mov_b32 v157, v2
    v_mov_b32 v158, v2
    v_mov_b32 v159, v2
    v_mov_b32 v160, v2
    v_mov_b32 v161, v2
    v_mov_b32 v162, v2
    v_mov_b32 v163, v2
    s_waitcnt lgkmcnt(4)
    v_mfma_f32_32x32x16_bf16 v[164:179], v[140:143], v[132:135], 0
    v_mov_b32 v196, 0
    v_mov_b32 v197, 0
    v_mov_b32 v198, 0
    v_mov_b32 v199, 0
    v_mov_b32 v200, 0
    v_mov_b32 v201, 0
    v_mov_b32 v202, 0
    v_mov_b32 v203, 0
    v_mov_b32 v204, 0
    v_mov_b32 v205, 0
    v_mov_b32 v206, 0
    v_mov_b32 v207, 0
    v_mov_b32 v208, 0
    v_mov_b32 v209, 0
    v_mov_b32 v210, 0
    v_mov_b32 v211, 0
    v_mov_b32 v212, 0
    v_mov_b32 v213, 0
    v_mov_b32 v214, 0
    v_mov_b32 v215, 0
    v_mov_b32 v216, 0
    v_mov_b32 v217, 0
    v_mov_b32 v218, 0
    v_mov_b32 v219, 0
    v_mov_b32 v220, 0
    v_mov_b32 v221, 0
    v_mov_b32 v222, 0
    v_mov_b32 v223, 0
    v_mov_b32 v224, 0
    v_mov_b32 v225, 0
    v_mov_b32 v226, 0
    v_mov_b32 v227, 0
    s_waitcnt lgkmcnt(0)
.p2align 3
    v_exp_f32 v164, v164
    v_exp_f32 v165, v165
    v_exp_f32 v166, v166
    v_exp_f32 v167, v167
    v_mfma_f32_32x32x16_bf16 v[180:195], v[140:143], v[136:139], 0
    s_mov_b64 exec, s[74:75]
    ds_read_b128 v[156:159], v9 offset:3072
    ds_read_b128 v[160:163], v9 offset:3584
    s_mov_b64 exec, -1
    v_exp_f32 v168, v168
    v_exp_f32 v169, v169
    v_exp_f32 v170, v170
    s_lshl_b32 s64, s62, 16
    s_lshl_b32 s77, s61, 10
    s_add_u32 s77, s77, s64
    s_lshl_b32 s76, s59, 17
    s_add_u32 s76, s76, s77
    s_add_u32 s76, s76, 2097152
    v_exp_f32 v171, v171
    v_exp_f32 v172, v172
    v_exp_f32 v173, v173
    v_smfmac_f32_32x32x32_bf16 v[196:211], v[148:151], v[164:171], v7
    v_exp_f32 v174, v174
    v_exp_f32 v175, v175
    v_exp_f32 v176, v176
    v_exp_f32 v177, v177
    v_exp_f32 v178, v178
    v_exp_f32 v179, v179
    v_exp_f32 v180, v180
    v_exp_f32 v181, v181
    v_smfmac_f32_32x32x32_bf16 v[196:211], v[152:155], v[172:179], v7
    v_exp_f32 v182, v182
    v_exp_f32 v183, v183
    s_waitcnt lgkmcnt(0)
    v_mfma_f32_32x32x16_bf16 v[164:179], v[144:147], v[132:135], 0
    ds_read_b128 v[140:143], v8 offset:4096
    v_exp_f32 v184, v184
    v_exp_f32 v185, v185
    v_exp_f32 v186, v186
    s_add_u32 m0, s77, 20480
    s_add_u32 s64, s76, 20480
    buffer_load_dwordx4 v6, s[16:19], s64 offen sc1 lds
    v_exp_f32 v187, v187
    v_exp_f32 v188, v188
    v_exp_f32 v189, v189
    v_smfmac_f32_32x32x32_bf16 v[212:227], v[148:151], v[180:187], v7
    v_exp_f32 v190, v190
    v_exp_f32 v191, v191
    v_exp_f32 v192, v192
    v_exp_f32 v193, v193
    v_exp_f32 v194, v194
    v_exp_f32 v195, v195
    v_exp_f32 v164, v164
    v_exp_f32 v165, v165
    v_smfmac_f32_32x32x32_bf16 v[212:227], v[152:155], v[188:195], v7
    v_exp_f32 v166, v166
    v_exp_f32 v167, v167
    v_mfma_f32_32x32x16_bf16 v[180:195], v[144:147], v[136:139], 0
    s_mov_b64 exec, s[74:75]
    ds_read_b128 v[148:151], v9 offset:5120
    ds_read_b128 v[152:155], v9 offset:5632
    s_mov_b64 exec, -1
    v_exp_f32 v168, v168
    v_exp_f32 v169, v169
    v_exp_f32 v170, v170
    s_add_u32 m0, s77, 24576
    s_add_u32 s64, s76, 24576
    buffer_load_dwordx4 v6, s[16:19], s64 offen sc1 lds
    s_mov_b32 s12, s48
    s_mov_b32 s13, s49
    s_mov_b32 s14, 0x158000
    s_mov_b32 s15, 0x20000
    v_exp_f32 v171, v171
    v_exp_f32 v172, v172
    v_exp_f32 v173, v173
    v_smfmac_f32_32x32x32_bf16 v[196:211], v[156:159], v[164:171], v7
    v_exp_f32 v174, v174
    v_exp_f32 v175, v175
    v_exp_f32 v176, v176
    v_exp_f32 v177, v177
    v_exp_f32 v178, v178
    v_exp_f32 v179, v179
    v_exp_f32 v180, v180
    v_exp_f32 v181, v181
    v_smfmac_f32_32x32x32_bf16 v[196:211], v[160:163], v[172:179], v7
    v_exp_f32 v182, v182
    v_exp_f32 v183, v183
    s_waitcnt lgkmcnt(0)
    v_mfma_f32_32x32x16_bf16 v[164:179], v[140:143], v[132:135], 0
    ds_read_b128 v[144:147], v8 offset:6144
    v_exp_f32 v184, v184
    v_exp_f32 v185, v185
    v_exp_f32 v186, v186
    s_add_u32 m0, s77, 28672
    s_add_u32 s64, s76, 28672
    buffer_load_dwordx4 v6, s[16:19], s64 offen sc1 lds
    s_mov_b32 s8, s36
    s_mov_b32 s9, s37
    s_mov_b32 s10, 0x200000
    s_mov_b32 s11, 0x20000
    v_exp_f32 v187, v187
    v_exp_f32 v188, v188
    v_exp_f32 v189, v189
    v_smfmac_f32_32x32x32_bf16 v[212:227], v[156:159], v[180:187], v7
    v_exp_f32 v190, v190
    v_exp_f32 v191, v191
    v_exp_f32 v192, v192
    v_exp_f32 v193, v193
    v_exp_f32 v194, v194
    v_exp_f32 v195, v195
    v_exp_f32 v164, v164
    v_exp_f32 v165, v165
    v_smfmac_f32_32x32x32_bf16 v[212:227], v[160:163], v[188:195], v7
    v_exp_f32 v166, v166
    v_exp_f32 v167, v167
    v_mfma_f32_32x32x16_bf16 v[180:195], v[140:143], v[136:139], 0
    s_mov_b64 exec, s[74:75]
    ds_read_b128 v[156:159], v9 offset:7168
    ds_read_b128 v[160:163], v9 offset:7680
    s_mov_b64 exec, -1
    v_exp_f32 v168, v168
    v_exp_f32 v169, v169
    v_exp_f32 v170, v170
    s_add_u32 m0, s77, 32768
    s_add_u32 s64, s76, 32768
    buffer_load_dwordx4 v6, s[16:19], s64 offen sc1 lds
    s_mov_b32 s20, s50
    s_mov_b32 s21, s51
    s_mov_b32 s22, 0x400
    s_mov_b32 s23, 0x20000
    v_exp_f32 v171, v171
    v_exp_f32 v172, v172
    v_exp_f32 v173, v173
    v_smfmac_f32_32x32x32_bf16 v[196:211], v[148:151], v[164:171], v7
    v_exp_f32 v174, v174
    v_exp_f32 v175, v175
    v_exp_f32 v176, v176
    v_exp_f32 v177, v177
    v_exp_f32 v178, v178
    v_exp_f32 v179, v179
    v_exp_f32 v180, v180
    v_exp_f32 v181, v181
    v_smfmac_f32_32x32x32_bf16 v[196:211], v[152:155], v[172:179], v7
    v_exp_f32 v182, v182
    v_exp_f32 v183, v183
    s_waitcnt lgkmcnt(0)
    v_mfma_f32_32x32x16_bf16 v[164:179], v[144:147], v[132:135], 0
    ds_read_b128 v[140:143], v8 offset:8192
    v_exp_f32 v184, v184
    v_exp_f32 v185, v185
    v_exp_f32 v186, v186
    s_mov_b32 s24, s40
    s_mov_b32 s25, s41
    s_mov_b32 s26, 0x80000
    s_mov_b32 s27, 0x20000
    v_exp_f32 v187, v187
    v_exp_f32 v188, v188
    v_exp_f32 v189, v189
    v_smfmac_f32_32x32x32_bf16 v[212:227], v[148:151], v[180:187], v7
    v_exp_f32 v190, v190
    v_exp_f32 v191, v191
    v_exp_f32 v192, v192
    v_exp_f32 v193, v193
    v_exp_f32 v194, v194
    v_exp_f32 v195, v195
    v_exp_f32 v164, v164
    v_exp_f32 v165, v165
    v_smfmac_f32_32x32x32_bf16 v[212:227], v[152:155], v[188:195], v7
    v_exp_f32 v166, v166
    v_exp_f32 v167, v167
    v_mfma_f32_32x32x16_bf16 v[180:195], v[144:147], v[136:139], 0
    s_mov_b64 exec, s[74:75]
    ds_read_b128 v[148:151], v9 offset:9216
    ds_read_b128 v[152:155], v9 offset:9728
    s_mov_b64 exec, -1
    v_exp_f32 v168, v168
    v_exp_f32 v169, v169
    v_exp_f32 v170, v170
    s_mov_b32 s28, s52
    s_mov_b32 s29, s53
    s_mov_b32 s30, 0x200000
    s_mov_b32 s31, 0x20000
    s_lshr_b32 s63, s58, 1
    s_and_b32 s68, s58, 1
    s_lshl_b32 s66, s59, 1
    s_add_u32 s66, s66, s68
    s_mul_i32 s65, s63, 22
    s_mul_i32 s4, s66, 118
    s_lshl_b32 s80, s63, 3
    s_add_u32 s80, s80, s4
    s_lshl_b32 s80, s80, 10
    s_add_u32 s80, s80, 8388608
    s_add_u32 s4, s4, s65
    s_add_u32 s4, s4, 32
    s_lshl_b32 s4, s4, 10
    s_add_u32 s4, s4, 8388608
    s_lshl_b32 s5, s65, 14
    s_lshl_b32 s67, s68, 13
    s_lshl_b32 s7, s60, 7
    s_add_u32 s7, s7, s67
    s_add_u32 s5, s5, s7
    s_lshl_b32 s6, s58, 10
    s_lshl_b32 s82, s63, 17
    s_add_u32 s82, s82, s7
    s_lshl_b32 s73, s66, 6
    s_add_u32 s73, s73, 7344128
    s_lshl_b32 s81, s59, 8
    s_lshl_b32 s64, s63, 5
    s_add_u32 s81, s81, 7348224
    s_lshl_b32 s69, s66, 15
    s_lshl_b32 s68, s60, 7
    s_add_u32 s68, s68, s64
    v_exp_f32 v171, v171
    v_exp_f32 v172, v172
    v_exp_f32 v173, v173
    v_smfmac_f32_32x32x32_bf16 v[196:211], v[156:159], v[164:171], v7
    v_exp_f32 v174, v174
    v_exp_f32 v175, v175
    v_exp_f32 v176, v176
    v_exp_f32 v177, v177
    v_exp_f32 v178, v178
    v_exp_f32 v179, v179
    v_exp_f32 v180, v180
    v_exp_f32 v181, v181
    v_smfmac_f32_32x32x32_bf16 v[196:211], v[160:163], v[172:179], v7
    v_exp_f32 v182, v182
    v_exp_f32 v183, v183
    s_waitcnt lgkmcnt(0)
    v_mfma_f32_32x32x16_bf16 v[164:179], v[140:143], v[132:135], 0
    ds_read_b128 v[144:147], v8 offset:10240
    v_exp_f32 v184, v184
    v_exp_f32 v185, v185
    v_exp_f32 v186, v186
    v_lshrrev_b32 v2, 3, v1
    v_and_b32 v3, 7, v1
    v_bfe_u32 v5, v1, 4, 1
    v_lshlrev_b32 v5, 2, v5
    v_xor_b32 v3, v3, v5
    v_lshlrev_b32 v3, 4, v3
    v_lshl_add_u32 v10, v2, 10, v3
    v_exp_f32 v187, v187
    v_exp_f32 v188, v188
    v_exp_f32 v189, v189
    v_smfmac_f32_32x32x32_bf16 v[212:227], v[156:159], v[180:187], v7
    v_exp_f32 v190, v190
    v_exp_f32 v191, v191
    v_exp_f32 v192, v192
    v_exp_f32 v193, v193
    v_exp_f32 v194, v194
    v_exp_f32 v195, v195
    v_exp_f32 v164, v164
    v_exp_f32 v165, v165
    v_smfmac_f32_32x32x32_bf16 v[212:227], v[160:163], v[188:195], v7
    v_exp_f32 v166, v166
    v_exp_f32 v167, v167
    v_mfma_f32_32x32x16_bf16 v[180:195], v[140:143], v[136:139], 0
    s_mov_b64 exec, s[74:75]
    ds_read_b128 v[156:159], v9 offset:11264
    ds_read_b128 v[160:163], v9 offset:11776
    s_mov_b64 exec, -1
    v_exp_f32 v168, v168
    v_exp_f32 v169, v169
    v_exp_f32 v170, v170
    s_cmp_eq_u32 s3, 0
    s_cbranch_scc1 L_hf_21
    s_waitcnt vmcnt(4)
    v_mov_b32 v2, 1
    v_mov_b32 v3, 0
    s_mov_b64 exec, 1
    buffer_store_dword v2, v3, s[16:19], s3 offen sc1
    s_mov_b64 exec, -1
L_hf_21:
    v_exp_f32 v171, v171
    v_exp_f32 v172, v172
    v_exp_f32 v173, v173
    v_smfmac_f32_32x32x32_bf16 v[196:211], v[148:151], v[164:171], v7
    v_exp_f32 v174, v174
    v_exp_f32 v175, v175
    v_exp_f32 v176, v176
    v_exp_f32 v177, v177
    v_exp_f32 v178, v178
    v_exp_f32 v179, v179
    v_exp_f32 v180, v180
    v_exp_f32 v181, v181
    v_smfmac_f32_32x32x32_bf16 v[196:211], v[152:155], v[172:179], v7
    v_exp_f32 v182, v182
    v_exp_f32 v183, v183
    s_waitcnt lgkmcnt(0)
    v_mfma_f32_32x32x16_bf16 v[164:179], v[144:147], v[132:135], 0
    ds_read_b128 v[140:143], v8 offset:12288
    v_exp_f32 v184, v184
    v_exp_f32 v185, v185
    v_exp_f32 v186, v186
    s_add_u32 m0, s6, 131072
    s_add_u32 s64, s5, 0
    buffer_load_dwordx4 v10, s[12:15], s64 offen lds
    v_exp_f32 v187, v187
    v_exp_f32 v188, v188
    v_exp_f32 v189, v189
    v_smfmac_f32_32x32x32_bf16 v[212:227], v[148:151], v[180:187], v7
    v_exp_f32 v190, v190
    v_exp_f32 v191, v191
    v_exp_f32 v192, v192
    v_exp_f32 v193, v193
    v_exp_f32 v194, v194
    v_exp_f32 v195, v195
    v_exp_f32 v164, v164
    v_exp_f32 v165, v165
    v_smfmac_f32_32x32x32_bf16 v[212:227], v[152:155], v[188:195], v7
    v_exp_f32 v166, v166
    v_exp_f32 v167, v167
    v_mfma_f32_32x32x16_bf16 v[180:195], v[144:147], v[136:139], 0
    s_mov_b64 exec, s[74:75]
    ds_read_b128 v[148:151], v9 offset:13312
    ds_read_b128 v[152:155], v9 offset:13824
    s_mov_b64 exec, -1
    v_exp_f32 v168, v168
    v_exp_f32 v169, v169
    v_exp_f32 v170, v170
    v_and_b32 v2, 31, v1
    v_lshrrev_b32 v3, 5, v1
    v_lshl_add_u32 v3, v3, 4, s68
    v_lshl_add_u32 v11, v2, 10, v3
    v_add_u32 v11, s69, v11
    buffer_load_dwordx4 v[28:31], v3, s[20:23], 0 offen
    buffer_load_dwordx4 v[24:27], v11, s[8:11], 0 offen
    v_exp_f32 v171, v171
    v_exp_f32 v172, v172
    v_exp_f32 v173, v173
    v_smfmac_f32_32x32x32_bf16 v[196:211], v[156:159], v[164:171], v7
    v_exp_f32 v174, v174
    v_exp_f32 v175, v175
    v_exp_f32 v176, v176
    v_exp_f32 v177, v177
    v_exp_f32 v178, v178
    v_exp_f32 v179, v179
    v_exp_f32 v180, v180
    v_exp_f32 v181, v181
    v_smfmac_f32_32x32x32_bf16 v[196:211], v[160:163], v[172:179], v7
    v_exp_f32 v182, v182
    v_exp_f32 v183, v183
    s_waitcnt lgkmcnt(0)
    v_mfma_f32_32x32x16_bf16 v[164:179], v[140:143], v[132:135], 0
    ds_read_b128 v[144:147], v8 offset:14336
    v_exp_f32 v184, v184
    v_exp_f32 v185, v185
    v_exp_f32 v186, v186
    v_exp_f32 v187, v187
    v_exp_f32 v188, v188
    v_exp_f32 v189, v189
    v_smfmac_f32_32x32x32_bf16 v[212:227], v[156:159], v[180:187], v7
    v_exp_f32 v190, v190
    v_exp_f32 v191, v191
    v_exp_f32 v192, v192
    v_exp_f32 v193, v193
    v_exp_f32 v194, v194
    v_exp_f32 v195, v195
    s_setprio 2
    v_exp_f32 v164, v164
    v_exp_f32 v165, v165
    v_smfmac_f32_32x32x32_bf16 v[212:227], v[160:163], v[188:195], v7
    v_exp_f32 v166, v166
    v_exp_f32 v167, v167
    v_mfma_f32_32x32x16_bf16 v[180:195], v[140:143], v[136:139], 0
    s_mov_b64 exec, s[74:75]
    ds_read_b128 v[156:159], v9 offset:15360
    ds_read_b128 v[160:163], v9 offset:15872
    s_mov_b64 exec, -1
    v_exp_f32 v168, v168
    v_exp_f32 v169, v169
    v_exp_f32 v170, v170
    v_lshrrev_b32 v2, 5, v1
    v_bfe_u32 v3, v1, 2, 2
    v_lshl_add_u32 v2, v2, 2, v3
    v_lshlrev_b32 v2, 7, v2
    v_bfe_u32 v3, v1, 3, 1
    v_bfe_u32 v4, v1, 4, 1
    v_lshl_add_u32 v3, v3, 1, v4
    v_exp_f32 v171, v171
    v_exp_f32 v172, v172
    v_exp_f32 v173, v173
    v_smfmac_f32_32x32x32_bf16 v[196:211], v[148:151], v[164:171], v7
    v_exp_f32 v174, v174
    v_exp_f32 v175, v175
    v_exp_f32 v176, v176
    v_exp_f32 v177, v177
    v_exp_f32 v178, v178
    v_exp_f32 v179, v179
    v_exp_f32 v180, v180
    v_exp_f32 v181, v181
    v_smfmac_f32_32x32x32_bf16 v[196:211], v[152:155], v[172:179], v7
    v_exp_f32 v182, v182
    v_exp_f32 v183, v183
    s_waitcnt lgkmcnt(0)
    v_mfma_f32_32x32x16_bf16 v[164:179], v[144:147], v[132:135], 0
    ds_read_b128 v[140:143], v8 offset:16384
    v_exp_f32 v184, v184
    v_exp_f32 v185, v185
    v_exp_f32 v186, v186
    v_xor_b32 v3, s63, v3
    v_and_b32 v4, 3, v1
    v_lshlrev_b32 v4, 3, v4
    v_lshl_add_u32 v3, v3, 5, v4
    s_lshl_b32 s68, s63, 11
    v_add3_u32 v14, v2, v3, s68
    v_xor_b32 v15, 64, v14
    v_and_b32 v13, 15, v1
    v_lshlrev_b32 v13, 2, v13
    v_lshlrev_b32 v20, 2, v1
    v_exp_f32 v187, v187
    v_exp_f32 v188, v188
    v_exp_f32 v189, v189
    v_smfmac_f32_32x32x32_bf16 v[212:227], v[148:151], v[180:187], v7
    v_exp_f32 v190, v190
    v_exp_f32 v191, v191
    v_exp_f32 v192, v192
    v_exp_f32 v193, v193
    v_exp_f32 v194, v194
    v_exp_f32 v195, v195
    v_exp_f32 v164, v164
    v_exp_f32 v165, v165
    v_smfmac_f32_32x32x32_bf16 v[212:227], v[152:155], v[188:195], v7
    v_exp_f32 v166, v166
    v_exp_f32 v167, v167
    v_mfma_f32_32x32x16_bf16 v[180:195], v[144:147], v[136:139], 0
    s_mov_b64 exec, s[74:75]
    ds_read_b128 v[148:151], v9 offset:17408
    ds_read_b128 v[152:155], v9 offset:17920
    s_mov_b64 exec, -1
    v_exp_f32 v168, v168
    v_exp_f32 v169, v169
    v_exp_f32 v170, v170
    v_and_b32 v21, 7, v1
    v_lshlrev_b32 v21, 10, v21
    v_lshrrev_b32 v3, 3, v1
    v_lshl_add_u32 v22, v3, 14, v21
    s_and_b32 s64, s59, 3
    s_lshl_b32 s64, s64, 1
    s_lshl_b32 s84, 0x03030303, s64
    s_mov_b32 s85, s84
    v_exp_f32 v171, v171
    v_exp_f32 v172, v172
    v_exp_f32 v173, v173
    v_smfmac_f32_32x32x32_bf16 v[196:211], v[156:159], v[164:171], v7
    v_exp_f32 v174, v174
    v_exp_f32 v175, v175
    v_exp_f32 v176, v176
    v_exp_f32 v177, v177
    v_exp_f32 v178, v178
    v_exp_f32 v179, v179
    v_exp_f32 v180, v180
    v_exp_f32 v181, v181
    v_smfmac_f32_32x32x32_bf16 v[196:211], v[160:163], v[172:179], v7
    v_exp_f32 v182, v182
    v_exp_f32 v183, v183
    s_waitcnt lgkmcnt(0)
    v_mfma_f32_32x32x16_bf16 v[164:179], v[140:143], v[132:135], 0
    ds_read_b128 v[144:147], v8 offset:18432
    v_exp_f32 v184, v184
    v_exp_f32 v185, v185
    v_exp_f32 v186, v186
    s_add_u32 s64, s5, 98304
    s_mov_b64 exec, s[84:85]
    buffer_load_dword v21, v22, s[12:15], s64 offen
    s_mov_b64 exec, -1
    v_exp_f32 v187, v187
    v_exp_f32 v188, v188
    v_exp_f32 v189, v189
    v_smfmac_f32_32x32x32_bf16 v[212:227], v[156:159], v[180:187], v7
    v_exp_f32 v190, v190
    v_exp_f32 v191, v191
    v_exp_f32 v192, v192
    v_exp_f32 v193, v193
    v_exp_f32 v194, v194
    v_exp_f32 v195, v195
    s_waitcnt vmcnt(3)
    s_barrier
    s_setprio 3
    v_exp_f32 v164, v164
    v_exp_f32 v165, v165
    v_smfmac_f32_32x32x32_bf16 v[212:227], v[160:163], v[188:195], v7
    v_exp_f32 v166, v166
    v_exp_f32 v167, v167
    v_mfma_f32_32x32x16_bf16 v[180:195], v[140:143], v[136:139], 0
    s_mov_b64 exec, s[74:75]
    ds_read_b128 v[156:159], v9 offset:19456
    ds_read_b128 v[160:163], v9 offset:19968
    s_mov_b64 exec, -1
    v_exp_f32 v168, v168
    v_exp_f32 v169, v169
    v_exp_f32 v170, v170
    s_add_u32 m0, s77, 36864
    s_add_u32 s64, s76, 36864
    buffer_load_dwordx4 v6, s[16:19], s64 offen sc1 lds
    v_exp_f32 v171, v171
    v_exp_f32 v172, v172
    v_exp_f32 v173, v173
    v_smfmac_f32_32x32x32_bf16 v[196:211], v[148:151], v[164:171], v7
    v_exp_f32 v174, v174
    v_exp_f32 v175, v175
    v_exp_f32 v176, v176
    v_exp_f32 v177, v177
    v_exp_f32 v178, v178
    v_exp_f32 v179, v179
    v_exp_f32 v180, v180
    v_exp_f32 v181, v181
    v_smfmac_f32_32x32x32_bf16 v[196:211], v[152:155], v[172:179], v7
    v_exp_f32 v182, v182
    v_exp_f32 v183, v183
    s_waitcnt lgkmcnt(0)
    v_mfma_f32_32x32x16_bf16 v[164:179], v[144:147], v[132:135], 0
    ds_read_b128 v[140:143], v8 offset:20480
    v_exp_f32 v184, v184
    v_exp_f32 v185, v185
    v_exp_f32 v186, v186
    s_add_u32 m0, s77, 40960
    s_add_u32 s64, s76, 40960
    buffer_load_dwordx4 v6, s[16:19], s64 offen sc1 lds
    s_add_u32 s64, s5, 229376
    s_mov_b64 exec, s[84:85]
    buffer_load_dword v21, v22, s[12:15], s64 offen
    s_mov_b64 exec, -1
    v_exp_f32 v187, v187
    v_exp_f32 v188, v188
    v_exp_f32 v189, v189
    v_smfmac_f32_32x32x32_bf16 v[212:227], v[148:151], v[180:187], v7
    v_exp_f32 v190, v190
    v_exp_f32 v191, v191
    v_exp_f32 v192, v192
    v_exp_f32 v193, v193
    v_exp_f32 v194, v194
    v_exp_f32 v195, v195
    v_exp_f32 v164, v164
    v_exp_f32 v165, v165
    v_smfmac_f32_32x32x32_bf16 v[212:227], v[152:155], v[188:195], v7
    v_exp_f32 v166, v166
    v_exp_f32 v167, v167
    v_mfma_f32_32x32x16_bf16 v[180:195], v[144:147], v[136:139], 0
    s_mov_b64 exec, s[74:75]
    ds_read_b128 v[148:151], v9 offset:21504
    ds_read_b128 v[152:155], v9 offset:22016
    s_mov_b64 exec, -1
    v_exp_f32 v168, v168
    v_exp_f32 v169, v169
    v_exp_f32 v170, v170
    s_add_u32 m0, s77, 45056
    s_add_u32 s64, s76, 45056
    buffer_load_dwordx4 v6, s[16:19], s64 offen sc1 lds
    v_exp_f32 v171, v171
    v_exp_f32 v172, v172
    v_exp_f32 v173, v173
    v_smfmac_f32_32x32x32_bf16 v[196:211], v[156:159], v[164:171], v7
    v_exp_f32 v174, v174
    v_exp_f32 v175, v175
    v_exp_f32 v176, v176
    v_exp_f32 v177, v177
    v_exp_f32 v178, v178
    v_exp_f32 v179, v179
    v_exp_f32 v180, v180
    v_exp_f32 v181, v181
    v_smfmac_f32_32x32x32_bf16 v[196:211], v[160:163], v[172:179], v7
    v_exp_f32 v182, v182
    v_exp_f32 v183, v183
    s_waitcnt lgkmcnt(0)
    v_mfma_f32_32x32x16_bf16 v[164:179], v[140:143], v[132:135], 0
    ds_read_b128 v[144:147], v8 offset:22528
    v_exp_f32 v184, v184
    v_exp_f32 v185, v185
    v_exp_f32 v186, v186
    s_add_u32 m0, s77, 49152
    s_add_u32 s64, s76, 49152
    buffer_load_dwordx4 v6, s[16:19], s64 offen sc1 lds
    v_exp_f32 v187, v187
    v_exp_f32 v188, v188
    v_exp_f32 v189, v189
    v_smfmac_f32_32x32x32_bf16 v[212:227], v[156:159], v[180:187], v7
    v_exp_f32 v190, v190
    v_exp_f32 v191, v191
    v_exp_f32 v192, v192
    v_exp_f32 v193, v193
    v_exp_f32 v194, v194
    v_exp_f32 v195, v195
    v_exp_f32 v164, v164
    v_exp_f32 v165, v165
    v_smfmac_f32_32x32x32_bf16 v[212:227], v[160:163], v[188:195], v7
    v_exp_f32 v166, v166
    v_exp_f32 v167, v167
    v_mfma_f32_32x32x16_bf16 v[180:195], v[140:143], v[136:139], 0
    s_mov_b64 exec, s[74:75]
    ds_read_b128 v[156:159], v9 offset:23552
    ds_read_b128 v[160:163], v9 offset:24064
    s_mov_b64 exec, -1
    v_exp_f32 v168, v168
    v_exp_f32 v169, v169
    v_exp_f32 v170, v170
    buffer_load_dword v12, v13, s[16:19], s73 offen sc1
    s_add_u32 m0, s6, 0
    s_add_u32 s64, s5, 16384
    buffer_load_dwordx4 v10, s[12:15], s64 offen lds
    v_exp_f32 v171, v171
    v_exp_f32 v172, v172
    v_exp_f32 v173, v173
    v_smfmac_f32_32x32x32_bf16 v[196:211], v[148:151], v[164:171], v7
    v_exp_f32 v174, v174
    v_exp_f32 v175, v175
    v_exp_f32 v176, v176
    v_exp_f32 v177, v177
    v_exp_f32 v178, v178
    v_exp_f32 v179, v179
    v_exp_f32 v180, v180
    v_exp_f32 v181, v181
    v_smfmac_f32_32x32x32_bf16 v[196:211], v[152:155], v[172:179], v7
    v_exp_f32 v182, v182
    v_exp_f32 v183, v183
    s_waitcnt lgkmcnt(0)
    v_mfma_f32_32x32x16_bf16 v[164:179], v[144:147], v[132:135], 0
    ds_read_b128 v[140:143], v8 offset:24576
    v_exp_f32 v184, v184
    v_exp_f32 v185, v185
    v_exp_f32 v186, v186
    s_add_u32 m0, s6, 8192
    s_add_u32 s64, s5, 32768
    buffer_load_dwordx4 v10, s[12:15], s64 offen lds
    v_exp_f32 v187, v187
    v_exp_f32 v188, v188
    v_exp_f32 v189, v189
    v_smfmac_f32_32x32x32_bf16 v[212:227], v[148:151], v[180:187], v7
    v_exp_f32 v190, v190
    v_exp_f32 v191, v191
    v_exp_f32 v192, v192
    v_exp_f32 v193, v193
    v_exp_f32 v194, v194
    v_exp_f32 v195, v195
    v_exp_f32 v164, v164
    v_exp_f32 v165, v165
    v_smfmac_f32_32x32x32_bf16 v[212:227], v[152:155], v[188:195], v7
    v_exp_f32 v166, v166
    v_exp_f32 v167, v167
    v_mfma_f32_32x32x16_bf16 v[180:195], v[144:147], v[136:139], 0
    s_mov_b64 exec, s[74:75]
    ds_read_b128 v[148:151], v9 offset:25600
    ds_read_b128 v[152:155], v9 offset:26112
    s_mov_b64 exec, -1
    v_exp_f32 v168, v168
    v_exp_f32 v169, v169
    v_exp_f32 v170, v170
    s_add_u32 m0, s6, 65536
    s_add_u32 s64, s5, 49152
    buffer_load_dwordx4 v10, s[12:15], s64 offen lds
    v_exp_f32 v171, v171
    v_exp_f32 v172, v172
    v_exp_f32 v173, v173
    v_smfmac_f32_32x32x32_bf16 v[196:211], v[156:159], v[164:171], v7
    v_exp_f32 v174, v174
    v_exp_f32 v175, v175
    v_exp_f32 v176, v176
    v_exp_f32 v177, v177
    v_exp_f32 v178, v178
    v_exp_f32 v179, v179
    v_exp_f32 v180, v180
    v_exp_f32 v181, v181
    v_smfmac_f32_32x32x32_bf16 v[196:211], v[160:163], v[172:179], v7
    v_exp_f32 v182, v182
    v_exp_f32 v183, v183
    s_waitcnt lgkmcnt(0)
    v_mfma_f32_32x32x16_bf16 v[164:179], v[140:143], v[132:135], 0
    ds_read_b128 v[144:147], v8 offset:26624
    v_exp_f32 v184, v184
    v_exp_f32 v185, v185
    v_exp_f32 v186, v186
    s_add_u32 m0, s6, 73728
    s_add_u32 s64, s5, 65536
    buffer_load_dwordx4 v10, s[12:15], s64 offen lds
    v_exp_f32 v187, v187
    v_exp_f32 v188, v188
    v_exp_f32 v189, v189
    v_smfmac_f32_32x32x32_bf16 v[212:227], v[156:159], v[180:187], v7
    v_exp_f32 v190, v190
    v_exp_f32 v191, v191
    v_exp_f32 v192, v192
    v_exp_f32 v193, v193
    v_exp_f32 v194, v194
    v_exp_f32 v195, v195
    v_exp_f32 v164, v164
    v_exp_f32 v165, v165
    v_smfmac_f32_32x32x32_bf16 v[212:227], v[160:163], v[188:195], v7
    v_exp_f32 v166, v166
    v_exp_f32 v167, v167
    v_mfma_f32_32x32x16_bf16 v[180:195], v[140:143], v[136:139], 0
    s_mov_b64 exec, s[74:75]
    ds_read_b128 v[156:159], v9 offset:27648
    ds_read_b128 v[160:163], v9 offset:28160
    s_mov_b64 exec, -1
    v_exp_f32 v168, v168
    v_exp_f32 v169, v169
    v_exp_f32 v170, v170
    s_waitcnt vmcnt(4)
L_pollh_22:
    v_cmp_eq_u32 vcc, 1, v12
    s_cmp_eq_u64 vcc, exec
    s_cbranch_scc1 L_pollh_22_ok
    s_sleep 2
    buffer_load_dword v12, v13, s[16:19], s73 offen sc1
    s_waitcnt vmcnt(0)
    s_branch L_pollh_22
L_pollh_22_ok:
    s_waitcnt vmcnt(11)
    v_permlane32_swap_b32 v24, v26
    v_permlane32_swap_b32 v25, v27
    v_permlane32_swap_b32 v28, v30
    v_permlane32_swap_b32 v29, v31
    v_lshlrev_b32 v32, 16, v24
    v_and_b32 v33, 0xffff0000, v24
    v_lshlrev_b32 v2, 16, v28
    v_and_b32 v3, 0xffff0000, v28
    v_add_f32 v32, v32, v2
    v_add_f32 v33, v33, v3
    v_lshlrev_b32 v34, 16, v25
    v_and_b32 v35, 0xffff0000, v25
    v_lshlrev_b32 v2, 16, v29
    v_and_b32 v3, 0xffff0000, v29
    v_add_f32 v34, v34, v2
    v_add_f32 v35, v35, v3
    v_exp_f32 v171, v171
    v_exp_f32 v172, v172
    v_exp_f32 v173, v173
    v_smfmac_f32_32x32x32_bf16 v[196:211], v[148:151], v[164:171], v7
    v_exp_f32 v174, v174
    v_exp_f32 v175, v175
    v_exp_f32 v176, v176
    v_exp_f32 v177, v177
    v_exp_f32 v178, v178
    v_exp_f32 v179, v179
    v_exp_f32 v180, v180
    v_exp_f32 v181, v181
    v_smfmac_f32_32x32x32_bf16 v[196:211], v[152:155], v[172:179], v7
    v_exp_f32 v182, v182
    v_exp_f32 v183, v183
    s_waitcnt lgkmcnt(0)
    v_mfma_f32_32x32x16_bf16 v[164:179], v[144:147], v[132:135], 0
    ds_read_b128 v[140:143], v8 offset:28672
    v_exp_f32 v184, v184
    v_exp_f32 v185, v185
    v_exp_f32 v186, v186
    s_add_u32 s64, s4, 0
    buffer_load_dwordx4 v[40:43], v6, s[16:19], s64 offen sc1
    v_exp_f32 v187, v187
    v_exp_f32 v188, v188
    v_exp_f32 v189, v189
    v_smfmac_f32_32x32x32_bf16 v[212:227], v[148:151], v[180:187], v7
    v_exp_f32 v190, v190
    v_exp_f32 v191, v191
    v_exp_f32 v192, v192
    v_exp_f32 v193, v193
    v_exp_f32 v194, v194
    v_exp_f32 v195, v195
    v_exp_f32 v164, v164
    v_exp_f32 v165, v165
    v_smfmac_f32_32x32x32_bf16 v[212:227], v[152:155], v[188:195], v7
    v_exp_f32 v166, v166
    v_exp_f32 v167, v167
    v_mfma_f32_32x32x16_bf16 v[180:195], v[144:147], v[136:139], 0
    s_mov_b64 exec, s[74:75]
    ds_read_b128 v[148:151], v9 offset:29696
    ds_read_b128 v[152:155], v9 offset:30208
    s_mov_b64 exec, -1
    v_exp_f32 v168, v168
    v_exp_f32 v169, v169
    v_exp_f32 v170, v170
    s_add_u32 s64, s4, 1024
    buffer_load_dwordx4 v[44:47], v6, s[16:19], s64 offen sc1
    v_lshlrev_b32 v36, 16, v26
    v_and_b32 v37, 0xffff0000, v26
    v_lshlrev_b32 v2, 16, v30
    v_and_b32 v3, 0xffff0000, v30
    v_add_f32 v36, v36, v2
    v_add_f32 v37, v37, v3
    v_lshlrev_b32 v38, 16, v27
    v_and_b32 v39, 0xffff0000, v27
    v_lshlrev_b32 v2, 16, v31
    v_and_b32 v3, 0xffff0000, v31
    v_add_f32 v38, v38, v2
    v_add_f32 v39, v39, v3
    v_exp_f32 v171, v171
    v_exp_f32 v172, v172
    v_exp_f32 v173, v173
    v_smfmac_f32_32x32x32_bf16 v[196:211], v[156:159], v[164:171], v7
    v_exp_f32 v174, v174
    v_exp_f32 v175, v175
    v_exp_f32 v176, v176
    v_exp_f32 v177, v177
    v_exp_f32 v178, v178
    v_exp_f32 v179, v179
    v_exp_f32 v180, v180
    v_exp_f32 v181, v181
    v_smfmac_f32_32x32x32_bf16 v[196:211], v[160:163], v[172:179], v7
    v_exp_f32 v182, v182
    v_exp_f32 v183, v183
    s_waitcnt lgkmcnt(0)
    v_mfma_f32_32x32x16_bf16 v[164:179], v[140:143], v[132:135], 0
    ds_read_b128 v[144:147], v8 offset:30720
    v_exp_f32 v184, v184
    v_exp_f32 v185, v185
    v_exp_f32 v186, v186
    s_add_u32 s64, s4, 2048
    buffer_load_dwordx4 v[48:51], v6, s[16:19], s64 offen sc1
    v_exp_f32 v187, v187
    v_exp_f32 v188, v188
    v_exp_f32 v189, v189
    v_smfmac_f32_32x32x32_bf16 v[212:227], v[156:159], v[180:187], v7
    v_exp_f32 v190, v190
    v_exp_f32 v191, v191
    v_exp_f32 v192, v192
    v_exp_f32 v193, v193
    v_exp_f32 v194, v194
    v_exp_f32 v195, v195
    s_setprio 2
    v_exp_f32 v164, v164
    v_exp_f32 v165, v165
    v_smfmac_f32_32x32x32_bf16 v[212:227], v[160:163], v[188:195], v7
    v_exp_f32 v166, v166
    v_exp_f32 v167, v167
    v_mfma_f32_32x32x16_bf16 v[180:195], v[140:143], v[136:139], 0
    s_mov_b64 exec, s[74:75]
    ds_read_b128 v[156:159], v9 offset:31744
    ds_read_b128 v[160:163], v9 offset:32256
    s_mov_b64 exec, -1
    v_exp_f32 v168, v168
    v_exp_f32 v169, v169
    v_exp_f32 v170, v170
    s_add_u32 s64, s4, 3072
    buffer_load_dwordx4 v[52:55], v6, s[16:19], s64 offen sc1
    s_mul_i32 s64, s58, 3072
    s_add_u32 s64, s64, 139264
    v_add_u32 v24, s64, v6
    s_xor_b32 s64, s58, 4
    s_mul_i32 s64, s64, 3072
    s_add_u32 s64, s64, 139264
    v_add_u32 v25, s64, v6
    s_lshl_b32 s78, s60, 3
    s_lshl_b32 s65, s61, 1
    s_add_u32 s78, s78, s65
    s_add_u32 s78, s78, s62
    s_mul_i32 s79, s78, 118
    s_add_u32 s79, s79, s59
    s_lshl_b32 s79, s79, 10
    s_add_u32 s79, s79, 8388608
    s_lshl_b32 s78, s78, 5
    s_add_u32 s78, s78, s59
    s_lshl_b32 s78, s78, 2
    s_add_u32 s78, s78, 7348224
    v_exp_f32 v171, v171
    v_exp_f32 v172, v172
    v_exp_f32 v173, v173
    v_smfmac_f32_32x32x32_bf16 v[196:211], v[148:151], v[164:171], v7
    v_exp_f32 v174, v174
    v_exp_f32 v175, v175
    v_exp_f32 v176, v176
    v_exp_f32 v177, v177
    v_exp_f32 v178, v178
    v_exp_f32 v179, v179
    v_exp_f32 v180, v180
    v_exp_f32 v181, v181
    v_smfmac_f32_32x32x32_bf16 v[196:211], v[152:155], v[172:179], v7
    v_exp_f32 v182, v182
    v_exp_f32 v183, v183
    s_waitcnt lgkmcnt(0)
    v_mfma_f32_32x32x16_bf16 v[164:179], v[144:147], v[132:135], 0
    ds_read_b128 v[140:143], v8 offset:32768
    v_exp_f32 v184, v184
    v_exp_f32 v185, v185
    v_exp_f32 v186, v186
    s_add_u32 s64, s4, 4096
    buffer_load_dwordx4 v[56:59], v6, s[16:19], s64 offen sc1
    v_exp_f32 v187, v187
    v_exp_f32 v188, v188
    v_exp_f32 v189, v189
    v_smfmac_f32_32x32x32_bf16 v[212:227], v[148:151], v[180:187], v7
    v_exp_f32 v190, v190
    v_exp_f32 v191, v191
    v_exp_f32 v192, v192
    v_exp_f32 v193, v193
    v_exp_f32 v194, v194
    v_exp_f32 v195, v195
    v_exp_f32 v164, v164
    v_exp_f32 v165, v165
    v_smfmac_f32_32x32x32_bf16 v[212:227], v[152:155], v[188:195], v7
    v_exp_f32 v166, v166
    v_exp_f32 v167, v167
    v_mfma_f32_32x32x16_bf16 v[180:195], v[144:147], v[136:139], 0
    s_mov_b64 exec, s[74:75]
    ds_read_b128 v[148:151], v9 offset:33792
    ds_read_b128 v[152:155], v9 offset:34304
    s_mov_b64 exec, -1
    v_exp_f32 v168, v168
    v_exp_f32 v169, v169
    v_exp_f32 v170, v170
    s_xor_b32 s64, s58, 0
    s_and_b32 s65, s64, 1
    s_mul_i32 s65, s65, 6144
    s_and_b32 s66, s64, 2
    s_and_b32 s64, s64, 4
    s_lshl_b32 s64, s64, 1
    s_add_u32 s64, s64, s66
    s_lshl_b32 s64, s64, 13
    s_add_u32 s64, s64, s65
    s_add_u32 s64, s64, 0
    v_add_u32 v16, s64, v6
    s_add_u32 s64, s82, 0
    s_mov_b64 exec, s[84:85]
    buffer_load_dword v21, v22, s[24:27], s64 offen
    s_mov_b64 exec, -1
    v_exp_f32 v171, v171
    v_exp_f32 v172, v172
    v_exp_f32 v173, v173
    v_smfmac_f32_32x32x32_bf16 v[196:211], v[156:159], v[164:171], v7
    v_exp_f32 v174, v174
    v_exp_f32 v175, v175
    v_exp_f32 v176, v176
    v_exp_f32 v177, v177
    v_exp_f32 v178, v178
    v_exp_f32 v179, v179
    v_exp_f32 v180, v180
    v_exp_f32 v181, v181
    v_smfmac_f32_32x32x32_bf16 v[196:211], v[160:163], v[172:179], v7
    v_exp_f32 v182, v182
    v_exp_f32 v183, v183
    s_waitcnt lgkmcnt(0)
    v_mfma_f32_32x32x16_bf16 v[164:179], v[140:143], v[132:135], 0
    ds_read_b128 v[144:147], v8 offset:34816
    v_exp_f32 v184, v184
    v_exp_f32 v185, v185
    v_exp_f32 v186, v186
    s_xor_b32 s64, s58, 2
    s_and_b32 s65, s64, 1
    s_mul_i32 s65, s65, 6144
    s_and_b32 s66, s64, 2
    s_and_b32 s64, s64, 4
    s_lshl_b32 s64, s64, 1
    s_add_u32 s64, s64, s66
    s_lshl_b32 s64, s64, 13
    s_add_u32 s64, s64, s65
    s_add_u32 s64, s64, 0
    v_add_u32 v17, s64, v6
    v_exp_f32 v187, v187
    v_exp_f32 v188, v188
    v_exp_f32 v189, v189
    v_smfmac_f32_32x32x32_bf16 v[212:227], v[156:159], v[180:187], v7
    v_exp_f32 v190, v190
    v_exp_f32 v191, v191
    v_exp_f32 v192, v192
    v_exp_f32 v193, v193
    v_exp_f32 v194, v194
    v_exp_f32 v195, v195
    s_waitcnt vmcnt(6)
    s_barrier
    s_setprio 3
    v_exp_f32 v164, v164
    v_exp_f32 v165, v165
    v_smfmac_f32_32x32x32_bf16 v[212:227], v[160:163], v[188:195], v7
    v_exp_f32 v166, v166
    v_exp_f32 v167, v167
    v_mfma_f32_32x32x16_bf16 v[180:195], v[140:143], v[136:139], 0
    s_mov_b64 exec, s[74:75]
    ds_read_b128 v[156:159], v9 offset:35840
    ds_read_b128 v[160:163], v9 offset:36352
    s_mov_b64 exec, -1
    v_add_u32 v14, 0x20000, v14
    v_add_u32 v15, 0x20000, v15
    ds_read_b64_tr_b16 v[92:93], v14 offset:0
    ds_read_b64_tr_b16 v[94:95], v14 offset:1024
    ds_read_b64_tr_b16 v[96:97], v15 offset:0
    ds_read_b64_tr_b16 v[98:99], v15 offset:1024
    v_exp_f32 v168, v168
    v_exp_f32 v169, v169
    v_exp_f32 v170, v170
    s_add_u32 m0, s77, 53248
    s_add_u32 s64, s76, 53248
    buffer_load_dwordx4 v6, s[16:19], s64 offen sc1 lds
    v_exp_f32 v171, v171
    v_exp_f32 v172, v172
    v_exp_f32 v173, v173
    v_smfmac_f32_32x32x32_bf16 v[196:211], v[148:151], v[164:171], v7
    v_exp_f32 v174, v174
    v_exp_f32 v175, v175
    v_exp_f32 v176, v176
    v_exp_f32 v177, v177
    v_exp_f32 v178, v178
    v_exp_f32 v179, v179
    v_exp_f32 v180, v180
    v_exp_f32 v181, v181
    v_smfmac_f32_32x32x32_bf16 v[196:211], v[152:155], v[172:179], v7
    v_exp_f32 v182, v182
    v_exp_f32 v183, v183
    s_waitcnt lgkmcnt(0)
    v_mfma_f32_32x32x16_bf16 v[164:179], v[144:147], v[132:135], 0
    ds_read_b128 v[140:143], v8 offset:36864
    v_exp_f32 v184, v184
    v_exp_f32 v185, v185
    v_exp_f32 v186, v186
    s_waitcnt vmcnt(6)
    v_mfma_f32_32x32x16_bf16 v[100:115], v[92:95], v[40:43], 0
    s_add_u32 m0, s77, 57344
    s_add_u32 s64, s76, 57344
    buffer_load_dwordx4 v6, s[16:19], s64 offen sc1 lds
    v_exp_f32 v187, v187
    v_exp_f32 v188, v188
    v_exp_f32 v189, v189
    v_smfmac_f32_32x32x32_bf16 v[212:227], v[148:151], v[180:187], v7
    v_exp_f32 v190, v190
    v_exp_f32 v191, v191
    v_exp_f32 v192, v192
    v_mfma_f32_32x32x16_bf16 v[116:131], v[96:99], v[40:43], 0
    v_exp_f32 v193, v193
    v_exp_f32 v194, v194
    v_exp_f32 v195, v195
    v_exp_f32 v164, v164
    v_exp_f32 v165, v165
    v_smfmac_f32_32x32x32_bf16 v[212:227], v[152:155], v[188:195], v7
    v_exp_f32 v166, v166
    v_exp_f32 v167, v167
    v_mfma_f32_32x32x16_bf16 v[180:195], v[144:147], v[136:139], 0
    s_mov_b64 exec, s[74:75]
    ds_read_b128 v[148:151], v9 offset:37888
    ds_read_b128 v[152:155], v9 offset:38400
    s_mov_b64 exec, -1
    v_add_u32 v14, 0xfffe0000, v14
    v_add_u32 v15, 0xfffe0000, v15
    ds_read_b64_tr_b16 v[92:93], v14 offset:0
    ds_read_b64_tr_b16 v[94:95], v14 offset:1024
    ds_read_b64_tr_b16 v[96:97], v15 offset:0
    ds_read_b64_tr_b16 v[98:99], v15 offset:1024
    v_exp_f32 v168, v168
    v_exp_f32 v169, v169
    v_exp_f32 v170, v170
    s_add_u32 m0, s77, 61440
    s_add_u32 s64, s76, 61440
    buffer_load_dwordx4 v6, s[16:19], s64 offen sc1 lds
    v_exp_f32 v171, v171
    v_exp_f32 v172, v172
    v_exp_f32 v173, v173
    v_smfmac_f32_32x32x32_bf16 v[196:211], v[156:159], v[164:171], v7
    v_exp_f32 v174, v174
    v_exp_f32 v175, v175
    v_exp_f32 v176, v176
    v_exp_f32 v177, v177
    v_exp_f32 v178, v178
    v_exp_f32 v179, v179
    v_exp_f32 v180, v180
    v_exp_f32 v181, v181
    v_smfmac_f32_32x32x32_bf16 v[196:211], v[160:163], v[172:179], v7
    v_exp_f32 v182, v182
    v_exp_f32 v183, v183
    s_waitcnt lgkmcnt(0)
    v_mfma_f32_32x32x16_bf16 v[164:179], v[140:143], v[132:135], 0
    ds_read_b128 v[144:147], v8 offset:38912
    v_exp_f32 v184, v184
    v_exp_f32 v185, v185
    v_exp_f32 v186, v186
    s_waitcnt vmcnt(7)
    v_mfma_f32_32x32x16_bf16 v[100:115], v[92:95], v[44:47], v[100:115]
    s_add_u32 m0, s6, 16384
    s_add_u32 s64, s5, 81920
    buffer_load_dwordx4 v10, s[12:15], s64 offen lds
    v_exp_f32 v187, v187
    v_exp_f32 v188, v188
    v_exp_f32 v189, v189
    v_smfmac_f32_32x32x32_bf16 v[212:227], v[156:159], v[180:187], v7
    v_exp_f32 v190, v190
    v_exp_f32 v191, v191
    v_exp_f32 v192, v192
    v_mfma_f32_32x32x16_bf16 v[116:131], v[96:99], v[44:47], v[116:131]
    v_exp_f32 v193, v193
    v_exp_f32 v194, v194
    v_exp_f32 v195, v195
    v_exp_f32 v164, v164
    v_exp_f32 v165, v165
    v_smfmac_f32_32x32x32_bf16 v[212:227], v[160:163], v[188:195], v7
    v_exp_f32 v166, v166
    v_exp_f32 v167, v167
    v_mfma_f32_32x32x16_bf16 v[180:195], v[140:143], v[136:139], 0
    s_mov_b64 exec, s[74:75]
    ds_read_b128 v[156:159], v9 offset:39936
    ds_read_b128 v[160:163], v9 offset:40448
    s_mov_b64 exec, -1
    ds_read_b64_tr_b16 v[92:93], v14 offset:8192
    ds_read_b64_tr_b16 v[94:95], v14 offset:9216
    ds_read_b64_tr_b16 v[96:97], v15 offset:8192
    ds_read_b64_tr_b16 v[98:99], v15 offset:9216
    v_exp_f32 v168, v168
    v_exp_f32 v169, v169
    v_exp_f32 v170, v170
    s_add_u32 m0, s6, 24576
    s_add_u32 s64, s5, 98304
    buffer_load_dwordx4 v10, s[12:15], s64 offen lds
    v_exp_f32 v171, v171
    v_exp_f32 v172, v172
    v_exp_f32 v173, v173
    v_smfmac_f32_32x32x32_bf16 v[196:211], v[148:151], v[164:171], v7
    v_exp_f32 v174, v174
    v_exp_f32 v175, v175
    v_exp_f32 v176, v176
    v_exp_f32 v177, v177
    v_exp_f32 v178, v178
    v_exp_f32 v179, v179
    v_exp_f32 v180, v180
    v_exp_f32 v181, v181
    v_smfmac_f32_32x32x32_bf16 v[196:211], v[152:155], v[172:179], v7
    v_exp_f32 v182, v182
    v_exp_f32 v183, v183
    s_waitcnt lgkmcnt(0)
    v_mfma_f32_32x32x16_bf16 v[164:179], v[144:147], v[132:135], 0
    ds_read_b128 v[140:143], v8 offset:40960
    v_exp_f32 v184, v184
    v_exp_f32 v185, v185
    v_exp_f32 v186, v186
    s_waitcnt vmcnt(8)
    v_mfma_f32_32x32x16_bf16 v[100:115], v[92:95], v[48:51], v[100:115]
    s_add_u32 m0, s6, 81920
    s_add_u32 s64, s5, 114688
    buffer_load_dwordx4 v10, s[12:15], s64 offen lds
    v_exp_f32 v187, v187
    v_exp_f32 v188, v188
    v_exp_f32 v189, v189
    v_smfmac_f32_32x32x32_bf16 v[212:227], v[148:151], v[180:187], v7
    v_exp_f32 v190, v190
    v_exp_f32 v191, v191
    v_exp_f32 v192, v192
    v_mfma_f32_32x32x16_bf16 v[116:131], v[96:99], v[48:51], v[116:131]
    v_exp_f32 v193, v193
    v_exp_f32 v194, v194
    v_exp_f32 v195, v195
    v_exp_f32 v164, v164
    v_exp_f32 v165, v165
    v_smfmac_f32_32x32x32_bf16 v[212:227], v[152:155], v[188:195], v7
    v_exp_f32 v166, v166
    v_exp_f32 v167, v167
    v_mfma_f32_32x32x16_bf16 v[180:195], v[144:147], v[136:139], 0
    s_mov_b64 exec, s[74:75]
    ds_read_b128 v[148:151], v9 offset:41984
    ds_read_b128 v[152:155], v9 offset:42496
    s_mov_b64 exec, -1
    v_add_u32 v14, 0x10000, v14
    v_add_u32 v15, 0x10000, v15
    ds_read_b64_tr_b16 v[92:93], v14 offset:0
    ds_read_b64_tr_b16 v[94:95], v14 offset:1024
    ds_read_b64_tr_b16 v[96:97], v15 offset:0
    ds_read_b64_tr_b16 v[98:99], v15 offset:1024
    v_exp_f32 v168, v168
    v_exp_f32 v169, v169
    v_exp_f32 v170, v170
    s_add_u32 m0, s6, 90112
    s_add_u32 s64, s5, 131072
    buffer_load_dwordx4 v10, s[12:15], s64 offen lds
    v_exp_f32 v171, v171
    v_exp_f32 v172, v172
    v_exp_f32 v173, v173
    v_smfmac_f32_32x32x32_bf16 v[196:211], v[156:159], v[164:171], v7
    v_exp_f32 v174, v174
    v_exp_f32 v175, v175
    v_exp_f32 v176, v176
    v_exp_f32 v177, v177
    v_exp_f32 v178, v178
    v_exp_f32 v179, v179
    v_exp_f32 v180, v180
    v_exp_f32 v181, v181
    v_smfmac_f32_32x32x32_bf16 v[196:211], v[160:163], v[172:179], v7
    v_exp_f32 v182, v182
    v_exp_f32 v183, v183
    s_waitcnt lgkmcnt(0)
    v_mfma_f32_32x32x16_bf16 v[164:179], v[140:143], v[132:135], 0
    ds_read_b128 v[144:147], v8 offset:43008
    v_exp_f32 v184, v184
    v_exp_f32 v185, v185
    v_exp_f32 v186, v186
    s_waitcnt vmcnt(9)
    v_mfma_f32_32x32x16_bf16 v[100:115], v[92:95], v[52:55], v[100:115]
    s_add_u32 s64, s4, 5120
    buffer_load_dwordx4 v[60:63], v6, s[16:19], s64 offen sc1
    v_exp_f32 v187, v187
    v_exp_f32 v188, v188
    v_exp_f32 v189, v189
    v_smfmac_f32_32x32x32_bf16 v[212:227], v[156:159], v[180:187], v7
    v_exp_f32 v190, v190
    v_exp_f32 v191, v191
    v_exp_f32 v192, v192
    v_mfma_f32_32x32x16_bf16 v[116:131], v[96:99], v[52:55], v[116:131]
    v_exp_f32 v193, v193
    v_exp_f32 v194, v194
    v_exp_f32 v195, v195
    v_exp_f32 v164, v164
    v_exp_f32 v165, v165
    v_smfmac_f32_32x32x32_bf16 v[212:227], v[160:163], v[188:195], v7
    v_exp_f32 v166, v166
    v_exp_f32 v167, v167
    v_mfma_f32_32x32x16_bf16 v[180:195], v[140:143], v[136:139], 0
    s_mov_b64 exec, s[74:75]
    ds_read_b128 v[156:159], v9 offset:44032
    ds_read_b128 v[160:163], v9 offset:44544
    s_mov_b64 exec, -1
    ds_read_b64_tr_b16 v[92:93], v14 offset:8192
    ds_read_b64_tr_b16 v[94:95], v14 offset:9216
    ds_read_b64_tr_b16 v[96:97], v15 offset:8192
    ds_read_b64_tr_b16 v[98:99], v15 offset:9216
    v_exp_f32 v168, v168
    v_exp_f32 v169, v169
    v_exp_f32 v170, v170
    s_add_u32 s64, s4, 6144
    buffer_load_dwordx4 v[64:67], v6, s[16:19], s64 offen sc1
    v_exp_f32 v171, v171
    v_exp_f32 v172, v172
    v_exp_f32 v173, v173
    v_smfmac_f32_32x32x32_bf16 v[196:211], v[148:151], v[164:171], v7
    v_exp_f32 v174, v174
    v_exp_f32 v175, v175
    v_exp_f32 v176, v176
    v_exp_f32 v177, v177
    v_exp_f32 v178, v178
    v_exp_f32 v179, v179
    v_exp_f32 v180, v180
    v_exp_f32 v181, v181
    v_smfmac_f32_32x32x32_bf16 v[196:211], v[152:155], v[172:179], v7
    v_exp_f32 v182, v182
    v_exp_f32 v183, v183
    s_waitcnt lgkmcnt(0)
    v_mfma_f32_32x32x16_bf16 v[164:179], v[144:147], v[132:135], 0
    ds_read_b128 v[140:143], v8 offset:45056
    v_exp_f32 v184, v184
    v_exp_f32 v185, v185
    v_exp_f32 v186, v186
    s_waitcnt vmcnt(10)
    v_mfma_f32_32x32x16_bf16 v[100:115], v[92:95], v[56:59], v[100:115]
    s_add_u32 s64, s4, 7168
    buffer_load_dwordx4 v[68:71], v6, s[16:19], s64 offen sc1
    v_exp_f32 v187, v187
    v_exp_f32 v188, v188
    v_exp_f32 v189, v189
    v_smfmac_f32_32x32x32_bf16 v[212:227], v[148:151], v[180:187], v7
    v_exp_f32 v190, v190
    v_exp_f32 v191, v191
    v_exp_f32 v192, v192
    v_mfma_f32_32x32x16_bf16 v[116:131], v[96:99], v[56:59], v[116:131]
    v_exp_f32 v193, v193
    v_exp_f32 v194, v194
    v_exp_f32 v195, v195
    v_exp_f32 v164, v164
    v_exp_f32 v165, v165
    v_smfmac_f32_32x32x32_bf16 v[212:227], v[152:155], v[188:195], v7
    v_exp_f32 v166, v166
    v_exp_f32 v167, v167
    v_mfma_f32_32x32x16_bf16 v[180:195], v[144:147], v[136:139], 0
    s_mov_b64 exec, s[74:75]
    ds_read_b128 v[148:151], v9 offset:46080
    ds_read_b128 v[152:155], v9 offset:46592
    s_mov_b64 exec, -1
    v_exp_f32 v168, v168
    v_exp_f32 v169, v169
    v_exp_f32 v170, v170
    s_xor_b32 s64, s58, 4
    s_and_b32 s65, s64, 1
    s_mul_i32 s65, s65, 6144
    s_and_b32 s66, s64, 2
    s_and_b32 s64, s64, 4
    s_lshl_b32 s64, s64, 1
    s_add_u32 s64, s64, s66
    s_lshl_b32 s64, s64, 13
    s_add_u32 s64, s64, s65
    s_add_u32 s64, s64, 2048
    v_add_u32 v18, s64, v6
    s_add_u32 s64, s4, 8192
    buffer_load_dwordx4 v[72:75], v6, s[16:19], s64 offen sc1
    v_exp_f32 v171, v171
    v_exp_f32 v172, v172
    v_exp_f32 v173, v173
    v_smfmac_f32_32x32x32_bf16 v[196:211], v[156:159], v[164:171], v7
    v_exp_f32 v174, v174
    v_exp_f32 v175, v175
    v_exp_f32 v176, v176
    v_exp_f32 v177, v177
    v_exp_f32 v178, v178
    v_exp_f32 v179, v179
    v_exp_f32 v180, v180
    v_exp_f32 v181, v181
    v_smfmac_f32_32x32x32_bf16 v[196:211], v[160:163], v[172:179], v7
    v_exp_f32 v182, v182
    v_exp_f32 v183, v183
    s_waitcnt lgkmcnt(0)
    v_mfma_f32_32x32x16_bf16 v[164:179], v[140:143], v[132:135], 0
    ds_read_b128 v[144:147], v8 offset:47104
    v_exp_f32 v184, v184
    v_exp_f32 v185, v185
    v_exp_f32 v186, v186
    s_xor_b32 s64, s58, 6
    s_and_b32 s65, s64, 1
    s_mul_i32 s65, s65, 6144
    s_and_b32 s66, s64, 2
    s_and_b32 s64, s64, 4
    s_lshl_b32 s64, s64, 1
    s_add_u32 s64, s64, s66
    s_lshl_b32 s64, s64, 13
    s_add_u32 s64, s64, s65
    s_add_u32 s64, s64, 4096
    v_add_u32 v19, s64, v6
    s_add_u32 s64, s4, 9216
    buffer_load_dwordx4 v[76:79], v6, s[16:19], s64 offen sc1
    v_exp_f32 v187, v187
    v_exp_f32 v188, v188
    v_exp_f32 v189, v189
    v_smfmac_f32_32x32x32_bf16 v[212:227], v[156:159], v[180:187], v7
    v_exp_f32 v190, v190
    v_exp_f32 v191, v191
    v_exp_f32 v192, v192
    v_exp_f32 v193, v193
    v_exp_f32 v194, v194
    v_exp_f32 v195, v195
    s_setprio 2
    v_exp_f32 v164, v164
    v_exp_f32 v165, v165
    v_smfmac_f32_32x32x32_bf16 v[212:227], v[160:163], v[188:195], v7
    v_exp_f32 v166, v166
    v_exp_f32 v167, v167
    v_mfma_f32_32x32x16_bf16 v[180:195], v[140:143], v[136:139], 0
    s_mov_b64 exec, s[74:75]
    ds_read_b128 v[156:159], v9 offset:48128
    ds_read_b128 v[160:163], v9 offset:48640
    s_mov_b64 exec, -1
    v_exp_f32 v168, v168
    v_exp_f32 v169, v169
    v_exp_f32 v170, v170
    s_add_u32 s64, s4, 10240
    buffer_load_dwordx4 v[80:83], v6, s[16:19], s64 offen sc1
    v_exp_f32 v171, v171
    v_exp_f32 v172, v172
    v_exp_f32 v173, v173
    v_smfmac_f32_32x32x32_bf16 v[196:211], v[148:151], v[164:171], v7
    v_exp_f32 v174, v174
    v_exp_f32 v175, v175
    v_exp_f32 v176, v176
    v_exp_f32 v177, v177
    v_exp_f32 v178, v178
    v_exp_f32 v179, v179
    v_exp_f32 v180, v180
    v_exp_f32 v181, v181
    v_smfmac_f32_32x32x32_bf16 v[196:211], v[152:155], v[172:179], v7
    v_exp_f32 v182, v182
    v_exp_f32 v183, v183
    s_waitcnt lgkmcnt(0)
    v_mfma_f32_32x32x16_bf16 v[164:179], v[144:147], v[132:135], 0
    ds_read_b128 v[140:143], v8 offset:49152
    v_exp_f32 v184, v184
    v_exp_f32 v185, v185
    v_exp_f32 v186, v186
    s_add_u32 s64, s4, 11264
    buffer_load_dwordx4 v[84:87], v6, s[16:19], s64 offen sc1
    v_exp_f32 v187, v187
    v_exp_f32 v188, v188
    v_exp_f32 v189, v189
    v_smfmac_f32_32x32x32_bf16 v[212:227], v[148:151], v[180:187], v7
    v_exp_f32 v190, v190
    v_exp_f32 v191, v191
    v_exp_f32 v192, v192
    v_exp_f32 v193, v193
    v_exp_f32 v194, v194
    v_exp_f32 v195, v195
    v_exp_f32 v164, v164
    v_exp_f32 v165, v165
    v_smfmac_f32_32x32x32_bf16 v[212:227], v[152:155], v[188:195], v7
    v_exp_f32 v166, v166
    v_exp_f32 v167, v167
    v_mfma_f32_32x32x16_bf16 v[180:195], v[144:147], v[136:139], 0
    s_mov_b64 exec, s[74:75]
    ds_read_b128 v[148:151], v9 offset:50176
    ds_read_b128 v[152:155], v9 offset:50688
    s_mov_b64 exec, -1
    v_exp_f32 v168, v168
    v_exp_f32 v169, v169
    v_exp_f32 v170, v170
    s_add_u32 s64, s4, 12288
    buffer_load_dwordx4 v[88:91], v6, s[16:19], s64 offen sc1
    v_exp_f32 v171, v171
    v_exp_f32 v172, v172
    v_exp_f32 v173, v173
    v_smfmac_f32_32x32x32_bf16 v[196:211], v[156:159], v[164:171], v7
    v_exp_f32 v174, v174
    v_exp_f32 v175, v175
    v_exp_f32 v176, v176
    v_exp_f32 v177, v177
    v_exp_f32 v178, v178
    v_exp_f32 v179, v179
    v_exp_f32 v180, v180
    v_exp_f32 v181, v181
    v_smfmac_f32_32x32x32_bf16 v[196:211], v[160:163], v[172:179], v7
    v_exp_f32 v182, v182
    v_exp_f32 v183, v183
    s_waitcnt lgkmcnt(0)
    v_mfma_f32_32x32x16_bf16 v[164:179], v[140:143], v[132:135], 0
    ds_read_b128 v[144:147], v8 offset:51200
    v_exp_f32 v184, v184
    v_exp_f32 v185, v185
    v_exp_f32 v186, v186
    v_exp_f32 v187, v187
    v_exp_f32 v188, v188
    v_exp_f32 v189, v189
    v_smfmac_f32_32x32x32_bf16 v[212:227], v[156:159], v[180:187], v7
    v_exp_f32 v190, v190
    v_exp_f32 v191, v191
    v_exp_f32 v192, v192
    v_exp_f32 v193, v193
    v_exp_f32 v194, v194
    v_exp_f32 v195, v195
    s_waitcnt vmcnt(8)
    s_barrier
    s_setprio 3
    v_exp_f32 v164, v164
    v_exp_f32 v165, v165
    v_smfmac_f32_32x32x32_bf16 v[212:227], v[160:163], v[188:195], v7
    v_exp_f32 v166, v166
    v_exp_f32 v167, v167
    v_mfma_f32_32x32x16_bf16 v[180:195], v[140:143], v[136:139], 0
    s_mov_b64 exec, s[74:75]
    ds_read_b128 v[156:159], v9 offset:52224
    ds_read_b128 v[160:163], v9 offset:52736
    s_mov_b64 exec, -1
    v_add_u32 v14, 0xffff0000, v14
    v_add_u32 v15, 0xffff0000, v15
    ds_read_b64_tr_b16 v[92:93], v14 offset:16384
    ds_read_b64_tr_b16 v[94:95], v14 offset:17408
    ds_read_b64_tr_b16 v[96:97], v15 offset:16384
    ds_read_b64_tr_b16 v[98:99], v15 offset:17408
    v_exp_f32 v168, v168
    v_exp_f32 v169, v169
    v_exp_f32 v170, v170
    s_add_u32 m0, s6, 32768
    s_add_u32 s64, s5, 147456
    buffer_load_dwordx4 v10, s[12:15], s64 offen lds
    s_add_u32 m0, s6, 40960
    s_add_u32 s64, s5, 163840
    buffer_load_dwordx4 v10, s[12:15], s64 offen lds
    v_exp_f32 v171, v171
    v_exp_f32 v172, v172
    v_exp_f32 v173, v173
    v_smfmac_f32_32x32x32_bf16 v[196:211], v[148:151], v[164:171], v7
    v_exp_f32 v174, v174
    v_exp_f32 v175, v175
    v_exp_f32 v176, v176
    v_exp_f32 v177, v177
    v_exp_f32 v178, v178
    v_exp_f32 v179, v179
    v_exp_f32 v180, v180
    v_exp_f32 v181, v181
    v_smfmac_f32_32x32x32_bf16 v[196:211], v[152:155], v[172:179], v7
    v_exp_f32 v182, v182
    v_exp_f32 v183, v183
    s_waitcnt lgkmcnt(0)
    v_mfma_f32_32x32x16_bf16 v[164:179], v[144:147], v[132:135], 0
    ds_read_b128 v[140:143], v8 offset:53248
    v_exp_f32 v184, v184
    v_exp_f32 v185, v185
    v_exp_f32 v186, v186
    s_waitcnt vmcnt(9)
    v_mfma_f32_32x32x16_bf16 v[100:115], v[92:95], v[60:63], v[100:115]
    s_add_u32 m0, s6, 98304
    s_add_u32 s64, s5, 180224
    buffer_load_dwordx4 v10, s[12:15], s64 offen lds
    s_add_u32 m0, s6, 106496
    s_add_u32 s64, s5, 196608
    buffer_load_dwordx4 v10, s[12:15], s64 offen lds
    v_exp_f32 v187, v187
    v_exp_f32 v188, v188
    v_exp_f32 v189, v189
    v_smfmac_f32_32x32x32_bf16 v[212:227], v[148:151], v[180:187], v7
    v_exp_f32 v190, v190
    v_exp_f32 v191, v191
    v_exp_f32 v192, v192
    v_mfma_f32_32x32x16_bf16 v[116:131], v[96:99], v[60:63], v[116:131]
    v_exp_f32 v193, v193
    v_exp_f32 v194, v194
    v_exp_f32 v195, v195
    v_exp_f32 v164, v164
    v_exp_f32 v165, v165
    v_smfmac_f32_32x32x32_bf16 v[212:227], v[152:155], v[188:195], v7
    v_exp_f32 v166, v166
    v_exp_f32 v167, v167
    v_mfma_f32_32x32x16_bf16 v[180:195], v[144:147], v[136:139], 0
    s_mov_b64 exec, s[74:75]
    ds_read_b128 v[148:151], v9 offset:54272
    ds_read_b128 v[152:155], v9 offset:54784
    s_mov_b64 exec, -1
    ds_read_b64_tr_b16 v[92:93], v14 offset:24576
    ds_read_b64_tr_b16 v[94:95], v14 offset:25600
    ds_read_b64_tr_b16 v[96:97], v15 offset:24576
    ds_read_b64_tr_b16 v[98:99], v15 offset:25600
    v_exp_f32 v168, v168
    v_exp_f32 v169, v169
    v_exp_f32 v170, v170
    s_add_u32 m0, s6, 131072
    s_add_u32 s64, s5, 212992
    buffer_load_dwordx4 v10, s[12:15], s64 offen lds
    s_add_u32 m0, s6, 0
    s_add_u32 s64, s5, 229376
    buffer_load_dwordx4 v10, s[12:15], s64 offen lds
    v_exp_f32 v171, v171
    v_exp_f32 v172, v172
    v_exp_f32 v173, v173
    v_smfmac_f32_32x32x32_bf16 v[196:211], v[156:159], v[164:171], v7
    v_exp_f32 v174, v174
    v_exp_f32 v175, v175
    v_exp_f32 v176, v176
    v_exp_f32 v177, v177
    v_exp_f32 v178, v178
    v_exp_f32 v179, v179
    v_exp_f32 v180, v180
    v_exp_f32 v181, v181
    v_smfmac_f32_32x32x32_bf16 v[196:211], v[160:163], v[172:179], v7
    v_exp_f32 v182, v182
    v_exp_f32 v183, v183
    s_waitcnt lgkmcnt(0)
    v_mfma_f32_32x32x16_bf16 v[164:179], v[140:143], v[132:135], 0
    ds_read_b128 v[144:147], v8 offset:55296
    v_exp_f32 v184, v184
    v_exp_f32 v185, v185
    v_exp_f32 v186, v186
    s_waitcnt vmcnt(12)
    v_mfma_f32_32x32x16_bf16 v[100:115], v[92:95], v[64:67], v[100:115]
    s_add_u32 m0, s6, 8192
    s_add_u32 s64, s5, 245760
    buffer_load_dwordx4 v10, s[12:15], s64 offen lds
    s_add_u32 m0, s6, 65536
    s_add_u32 s64, s5, 262144
    buffer_load_dwordx4 v10, s[12:15], s64 offen lds
    v_exp_f32 v187, v187
    v_exp_f32 v188, v188
    v_exp_f32 v189, v189
    v_smfmac_f32_32x32x32_bf16 v[212:227], v[156:159], v[180:187], v7
    v_exp_f32 v190, v190
    v_exp_f32 v191, v191
    v_exp_f32 v192, v192
    v_mfma_f32_32x32x16_bf16 v[116:131], v[96:99], v[64:67], v[116:131]
    v_exp_f32 v193, v193
    v_exp_f32 v194, v194
    v_exp_f32 v195, v195
    s_setprio 2
    v_exp_f32 v164, v164
    v_exp_f32 v165, v165
    v_smfmac_f32_32x32x32_bf16 v[212:227], v[160:163], v[188:195], v7
    v_exp_f32 v166, v166
    v_exp_f32 v167, v167
    v_mfma_f32_32x32x16_bf16 v[180:195], v[140:143], v[136:139], 0
    s_mov_b64 exec, s[74:75]
    ds_read_b128 v[156:159], v9 offset:56320
    ds_read_b128 v[160:163], v9 offset:56832
    s_mov_b64 exec, -1
    v_add_u32 v14, 0x10000, v14
    v_add_u32 v15, 0x10000, v15
    ds_read_b64_tr_b16 v[92:93], v14 offset:16384
    ds_read_b64_tr_b16 v[94:95], v14 offset:17408
    ds_read_b64_tr_b16 v[96:97], v15 offset:16384
    ds_read_b64_tr_b16 v[98:99], v15 offset:17408
    v_exp_f32 v168, v168
    v_exp_f32 v169, v169
    v_exp_f32 v170, v170
    s_add_u32 m0, s6, 73728
    s_add_u32 s64, s5, 278528
    buffer_load_dwordx4 v10, s[12:15], s64 offen lds
    v_exp_f32 v171, v171
    v_exp_f32 v172, v172
    v_exp_f32 v173, v173
    v_smfmac_f32_32x32x32_bf16 v[196:211], v[148:151], v[164:171], v7
    v_exp_f32 v174, v174
    v_exp_f32 v175, v175
    v_exp_f32 v176, v176
    v_exp_f32 v177, v177
    v_exp_f32 v178, v178
    v_exp_f32 v179, v179
    v_exp_f32 v180, v180
    v_exp_f32 v181, v181
    v_smfmac_f32_32x32x32_bf16 v[196:211], v[152:155], v[172:179], v7
    v_exp_f32 v182, v182
    v_exp_f32 v183, v183
    s_waitcnt lgkmcnt(0)
    v_mfma_f32_32x32x16_bf16 v[164:179], v[144:147], v[132:135], 0
    ds_read_b128 v[140:143], v8 offset:57344
    v_exp_f32 v184, v184
    v_exp_f32 v185, v185
    v_exp_f32 v186, v186
    s_waitcnt vmcnt(14)
    v_mfma_f32_32x32x16_bf16 v[100:115], v[92:95], v[68:71], v[100:115]
    s_add_u32 s64, s4, 13312
    buffer_load_dwordx4 v[40:43], v6, s[16:19], s64 offen sc1
    s_add_u32 s64, s4, 14336
    buffer_load_dwordx4 v[44:47], v6, s[16:19], s64 offen sc1
    v_exp_f32 v187, v187
    v_exp_f32 v188, v188
    v_exp_f32 v189, v189
    v_smfmac_f32_32x32x32_bf16 v[212:227], v[148:151], v[180:187], v7
    v_exp_f32 v190, v190
    v_exp_f32 v191, v191
    v_exp_f32 v192, v192
    v_mfma_f32_32x32x16_bf16 v[116:131], v[96:99], v[68:71], v[116:131]
    v_exp_f32 v193, v193
    v_exp_f32 v194, v194
    v_exp_f32 v195, v195
    v_exp_f32 v164, v164
    v_exp_f32 v165, v165
    v_smfmac_f32_32x32x32_bf16 v[212:227], v[152:155], v[188:195], v7
    v_exp_f32 v166, v166
    v_exp_f32 v167, v167
    v_mfma_f32_32x32x16_bf16 v[180:195], v[144:147], v[136:139], 0
    s_mov_b64 exec, s[74:75]
    ds_read_b128 v[148:151], v9 offset:58368
    ds_read_b128 v[152:155], v9 offset:58880
    s_mov_b64 exec, -1
    ds_read_b64_tr_b16 v[92:93], v14 offset:24576
    ds_read_b64_tr_b16 v[94:95], v14 offset:25600
    ds_read_b64_tr_b16 v[96:97], v15 offset:24576
    ds_read_b64_tr_b16 v[98:99], v15 offset:25600
    v_exp_f32 v168, v168
    v_exp_f32 v169, v169
    v_exp_f32 v170, v170
    s_add_u32 s64, s4, 15360
    buffer_load_dwordx4 v[48:51], v6, s[16:19], s64 offen sc1
    s_add_u32 s64, s4, 16384
    buffer_load_dwordx4 v[52:55], v6, s[16:19], s64 offen sc1
    v_exp_f32 v171, v171
    v_exp_f32 v172, v172
    v_exp_f32 v173, v173
    v_smfmac_f32_32x32x32_bf16 v[196:211], v[156:159], v[164:171], v7
    v_exp_f32 v174, v174
    v_exp_f32 v175, v175
    v_exp_f32 v176, v176
    v_exp_f32 v177, v177
    v_exp_f32 v178, v178
    v_exp_f32 v179, v179
    v_exp_f32 v180, v180
    v_exp_f32 v181, v181
    v_smfmac_f32_32x32x32_bf16 v[196:211], v[160:163], v[172:179], v7
    v_exp_f32 v182, v182
    v_exp_f32 v183, v183
    s_waitcnt lgkmcnt(0)
    v_mfma_f32_32x32x16_bf16 v[164:179], v[140:143], v[132:135], 0
    ds_read_b128 v[144:147], v8 offset:59392
    v_exp_f32 v184, v184
    v_exp_f32 v185, v185
    v_exp_f32 v186, v186
    s_waitcnt vmcnt(17)
    v_mfma_f32_32x32x16_bf16 v[100:115], v[92:95], v[72:75], v[100:115]
    s_add_u32 s64, s4, 17408
    buffer_load_dwordx4 v[56:59], v6, s[16:19], s64 offen sc1
    v_exp_f32 v187, v187
    v_exp_f32 v188, v188
    v_exp_f32 v189, v189
    v_smfmac_f32_32x32x32_bf16 v[212:227], v[156:159], v[180:187], v7
    v_exp_f32 v190, v190
    v_exp_f32 v191, v191
    v_exp_f32 v192, v192
    v_mfma_f32_32x32x16_bf16 v[116:131], v[96:99], v[72:75], v[116:131]
    v_exp_f32 v193, v193
    v_exp_f32 v194, v194
    v_exp_f32 v195, v195
    s_waitcnt vmcnt(5)
    s_barrier
    s_setprio 3
    v_exp_f32 v164, v164
    v_exp_f32 v165, v165
    v_smfmac_f32_32x32x32_bf16 v[212:227], v[160:163], v[188:195], v7
    v_exp_f32 v166, v166
    v_exp_f32 v167, v167
    v_mfma_f32_32x32x16_bf16 v[180:195], v[140:143], v[136:139], 0
    s_mov_b64 exec, s[74:75]
    ds_read_b128 v[156:159], v9 offset:60416
    ds_read_b128 v[160:163], v9 offset:60928
    s_mov_b64 exec, -1
    v_add_u32 v14, 0xffff0000, v14
    v_add_u32 v15, 0xffff0000, v15
    ds_read_b64_tr_b16 v[92:93], v14 offset:32768
    ds_read_b64_tr_b16 v[94:95], v14 offset:33792
    ds_read_b64_tr_b16 v[96:97], v15 offset:32768
    ds_read_b64_tr_b16 v[98:99], v15 offset:33792
    v_exp_f32 v168, v168
    v_exp_f32 v169, v169
    v_exp_f32 v170, v170
    s_add_u32 m0, s6, 16384
    s_add_u32 s64, s5, 294912
    buffer_load_dwordx4 v10, s[12:15], s64 offen lds
    s_add_u32 m0, s6, 24576
    s_add_u32 s64, s5, 311296
    buffer_load_dwordx4 v10, s[12:15], s64 offen lds
    v_exp_f32 v171, v171
    v_exp_f32 v172, v172
    v_exp_f32 v173, v173
    v_smfmac_f32_32x32x32_bf16 v[196:211], v[148:151], v[164:171], v7
    v_exp_f32 v174, v174
    v_exp_f32 v175, v175
    v_exp_f32 v176, v176
    v_exp_f32 v177, v177
    v_exp_f32 v178, v178
    v_exp_f32 v179, v179
    v_exp_f32 v180, v180
    v_exp_f32 v181, v181
    v_smfmac_f32_32x32x32_bf16 v[196:211], v[152:155], v[172:179], v7
    v_exp_f32 v182, v182
    v_exp_f32 v183, v183
    s_waitcnt lgkmcnt(0)
    v_mfma_f32_32x32x16_bf16 v[164:179], v[144:147], v[132:135], 0
    ds_read_b128 v[140:143], v8 offset:61440
    v_exp_f32 v184, v184
    v_exp_f32 v185, v185
    v_exp_f32 v186, v186
    s_waitcnt vmcnt(19)
    v_mfma_f32_32x32x16_bf16 v[100:115], v[92:95], v[76:79], v[100:115]
    s_add_u32 m0, s6, 81920
    s_add_u32 s64, s5, 327680
    buffer_load_dwordx4 v10, s[12:15], s64 offen lds
    s_add_u32 m0, s6, 90112
    s_add_u32 s64, s5, 344064
    buffer_load_dwordx4 v10, s[12:15], s64 offen lds
    v_exp_f32 v187, v187
    v_exp_f32 v188, v188
    v_exp_f32 v189, v189
    v_smfmac_f32_32x32x32_bf16 v[212:227], v[148:151], v[180:187], v7
    v_exp_f32 v190, v190
    v_exp_f32 v191, v191
    v_exp_f32 v192, v192
    v_mfma_f32_32x32x16_bf16 v[116:131], v[96:99], v[76:79], v[116:131]
    v_exp_f32 v193, v193
    v_exp_f32 v194, v194
    v_exp_f32 v195, v195
    v_exp_f32 v164, v164
    v_exp_f32 v165, v165
    v_smfmac_f32_32x32x32_bf16 v[212:227], v[152:155], v[188:195], v7
    v_exp_f32 v166, v166
    v_exp_f32 v167, v167
    v_mfma_f32_32x32x16_bf16 v[180:195], v[144:147], v[136:139], 0
    s_mov_b64 exec, s[74:75]
    ds_read_b128 v[148:151], v9 offset:62464
    ds_read_b128 v[152:155], v9 offset:62976
    s_mov_b64 exec, -1
    ds_read_b64_tr_b16 v[92:93], v14 offset:40960
    ds_read_b64_tr_b16 v[94:95], v14 offset:41984
    ds_read_b64_tr_b16 v[96:97], v15 offset:40960
    ds_read_b64_tr_b16 v[98:99], v15 offset:41984
    v_exp_f32 v168, v168
    v_exp_f32 v169, v169
    v_exp_f32 v170, v170
    s_add_u32 m0, s6, 114688
    s_add_u32 s64, s82, 0
    buffer_load_dwordx4 v10, s[24:27], s64 offen lds
    s_add_u32 m0, s6, 49152
    s_add_u32 s64, s82, 16384
    buffer_load_dwordx4 v10, s[24:27], s64 offen lds
    v_exp_f32 v171, v171
    v_exp_f32 v172, v172
    v_exp_f32 v173, v173
    v_smfmac_f32_32x32x32_bf16 v[196:211], v[156:159], v[164:171], v7
    v_exp_f32 v174, v174
    v_exp_f32 v175, v175
    v_exp_f32 v176, v176
    v_exp_f32 v177, v177
    v_exp_f32 v178, v178
    v_exp_f32 v179, v179
    v_exp_f32 v180, v180
    v_exp_f32 v181, v181
    v_smfmac_f32_32x32x32_bf16 v[196:211], v[160:163], v[172:179], v7
    v_exp_f32 v182, v182
    v_exp_f32 v183, v183
    s_waitcnt lgkmcnt(0)
    v_mfma_f32_32x32x16_bf16 v[164:179], v[140:143], v[132:135], 0
    ds_read_b128 v[144:147], v8 offset:63488
    v_exp_f32 v184, v184
    v_exp_f32 v185, v185
    v_exp_f32 v186, v186
    s_waitcnt vmcnt(22)
    v_mfma_f32_32x32x16_bf16 v[100:115], v[92:95], v[80:83], v[100:115]
    s_add_u32 s64, s4, 18432
    buffer_load_dwordx4 v[60:63], v6, s[16:19], s64 offen sc1
    v_exp_f32 v187, v187
    v_exp_f32 v188, v188
    v_exp_f32 v189, v189
    v_smfmac_f32_32x32x32_bf16 v[212:227], v[156:159], v[180:187], v7
    v_exp_f32 v190, v190
    v_exp_f32 v191, v191
    v_exp_f32 v192, v192
    v_mfma_f32_32x32x16_bf16 v[116:131], v[96:99], v[80:83], v[116:131]
    v_exp_f32 v193, v193
    v_exp_f32 v194, v194
    v_exp_f32 v195, v195
    s_setprio 2
    v_exp_f32 v164, v164
    v_exp_f32 v165, v165
    v_smfmac_f32_32x32x32_bf16 v[212:227], v[160:163], v[188:195], v7
    v_exp_f32 v166, v166
    v_exp_f32 v167, v167
    v_mfma_f32_32x32x16_bf16 v[180:195], v[140:143], v[136:139], 0
    s_mov_b64 exec, s[74:75]
    ds_read_b128 v[156:159], v9 offset:64512
    ds_read_b128 v[160:163], v9 offset:65024
    s_mov_b64 exec, -1
    v_add_u32 v14, 0x10000, v14
    v_add_u32 v15, 0x10000, v15
    ds_read_b64_tr_b16 v[92:93], v14 offset:32768
    ds_read_b64_tr_b16 v[94:95], v14 offset:33792
    ds_read_b64_tr_b16 v[96:97], v15 offset:32768
    ds_read_b64_tr_b16 v[98:99], v15 offset:33792
    v_exp_f32 v168, v168
    v_exp_f32 v169, v169
    v_exp_f32 v170, v170
    s_add_u32 s64, s4, 19456
    buffer_load_dwordx4 v[64:67], v6, s[16:19], s64 offen sc1
    v_exp_f32 v171, v171
    v_exp_f32 v172, v172
    v_exp_f32 v173, v173
    v_smfmac_f32_32x32x32_bf16 v[196:211], v[148:151], v[164:171], v7
    v_exp_f32 v174, v174
    v_exp_f32 v175, v175
    v_exp_f32 v176, v176
    v_exp_f32 v177, v177
    v_exp_f32 v178, v178
    v_exp_f32 v179, v179
    v_exp_f32 v180, v180
    v_exp_f32 v181, v181
    v_smfmac_f32_32x32x32_bf16 v[196:211], v[152:155], v[172:179], v7
    v_exp_f32 v182, v182
    v_exp_f32 v183, v183
    s_waitcnt lgkmcnt(0)
    v_mfma_f32_32x32x16_bf16 v[164:179], v[144:147], v[132:135], 0
    v_exp_f32 v184, v184
    v_exp_f32 v185, v185
    v_exp_f32 v186, v186
    s_waitcnt vmcnt(23)
    v_mfma_f32_32x32x16_bf16 v[100:115], v[92:95], v[84:87], v[100:115]
    s_cmp_eq_u32 s63, 3
    s_cbranch_scc1 L_hs_23
    s_add_u32 s64, s4, 20480
    buffer_load_dwordx4 v[68:71], v6, s[16:19], s64 offen sc1
L_hs_23:
    v_exp_f32 v187, v187
    v_exp_f32 v188, v188
    v_exp_f32 v189, v189
    v_smfmac_f32_32x32x32_bf16 v[212:227], v[148:151], v[180:187], v7
    v_exp_f32 v190, v190
    v_exp_f32 v191, v191
    v_exp_f32 v192, v192
    v_mfma_f32_32x32x16_bf16 v[116:131], v[96:99], v[84:87], v[116:131]
    v_exp_f32 v193, v193
    v_exp_f32 v194, v194
    v_exp_f32 v195, v195
    v_exp_f32 v164, v164
    v_exp_f32 v165, v165
    v_smfmac_f32_32x32x32_bf16 v[212:227], v[152:155], v[188:195], v7
    v_exp_f32 v166, v166
    v_exp_f32 v167, v167
    v_mfma_f32_32x32x16_bf16 v[180:195], v[144:147], v[136:139], 0
    ds_read_b64_tr_b16 v[92:93], v14 offset:40960
    ds_read_b64_tr_b16 v[94:95], v14 offset:41984
    ds_read_b64_tr_b16 v[96:97], v15 offset:40960
    ds_read_b64_tr_b16 v[98:99], v15 offset:41984
    v_exp_f32 v168, v168
    v_exp_f32 v169, v169
    v_exp_f32 v170, v170
    s_cmp_eq_u32 s63, 3
    s_cbranch_scc1 L_hs_24
    s_add_u32 s64, s4, 21504
    buffer_load_dwordx4 v[72:75], v6, s[16:19], s64 offen sc1
L_hs_24:
    v_exp_f32 v171, v171
    v_exp_f32 v172, v172
    v_exp_f32 v173, v173
    v_smfmac_f32_32x32x32_bf16 v[196:211], v[156:159], v[164:171], v7
    v_exp_f32 v174, v174
    v_exp_f32 v175, v175
    v_exp_f32 v176, v176
    v_exp_f32 v177, v177
    v_exp_f32 v178, v178
    v_exp_f32 v179, v179
    v_exp_f32 v180, v180
    v_exp_f32 v181, v181
    v_smfmac_f32_32x32x32_bf16 v[196:211], v[160:163], v[172:179], v7
    v_exp_f32 v182, v182
    v_exp_f32 v183, v183
    s_waitcnt lgkmcnt(0)
    v_exp_f32 v184, v184
    v_exp_f32 v185, v185
    v_exp_f32 v186, v186
    s_waitcnt vmcnt(22)
    v_mfma_f32_32x32x16_bf16 v[100:115], v[92:95], v[88:91], v[100:115]
    v_exp_f32 v187, v187
    v_exp_f32 v188, v188
    v_exp_f32 v189, v189
    v_smfmac_f32_32x32x32_bf16 v[212:227], v[156:159], v[180:187], v7
    v_exp_f32 v190, v190
    v_exp_f32 v191, v191
    v_exp_f32 v192, v192
    v_mfma_f32_32x32x16_bf16 v[116:131], v[96:99], v[88:91], v[116:131]
    v_exp_f32 v193, v193
    v_exp_f32 v194, v194
    v_exp_f32 v195, v195
    s_setprio 0
    s_cmp_eq_u32 s62, 0
    v_smfmac_f32_32x32x32_bf16 v[212:227], v[160:163], v[188:195], v7
    s_cselect_b64 vcc, -1, 0
    s_nop 10
    v_cndmask_b32 v164, v196, v212, vcc
    v_cndmask_b32 v165, v197, v213, vcc
    v_cndmask_b32 v166, v198, v214, vcc
    v_cndmask_b32 v167, v199, v215, vcc
    v_cndmask_b32 v168, v200, v216, vcc
    v_cndmask_b32 v169, v201, v217, vcc
    v_cndmask_b32 v170, v202, v218, vcc
    v_cndmask_b32 v171, v203, v219, vcc
    v_cndmask_b32 v172, v204, v220, vcc
    ds_write_b128 v24, v[164:167] offset:0
    ds_write_b128 v24, v[168:171] offset:1024
    ds_write_b128 v24, v[172:175] offset:2048
    v_cndmask_b32 v180, v212, v196, vcc
    v_cndmask_b32 v181, v213, v197, vcc
    v_cndmask_b32 v182, v214, v198, vcc
    v_cndmask_b32 v183, v215, v199, vcc
    v_cndmask_b32 v184, v216, v200, vcc
    v_cndmask_b32 v185, v217, v201, vcc
    v_cndmask_b32 v186, v218, v202, vcc
    v_cndmask_b32 v187, v219, v203, vcc
    v_cndmask_b32 v188, v220, v204, vcc
    s_waitcnt vmcnt(0) lgkmcnt(0)
    s_barrier
    ds_read_b128 v[164:167], v25 offset:0
    ds_read_b128 v[168:171], v25 offset:1024
    ds_read_b128 v[172:175], v25 offset:2048
    v_add_u32 v14, 0xffff0000, v14
    v_add_u32 v15, 0xffff0000, v15
    ds_read_b64_tr_b16 v[92:93], v14 offset:0
    ds_read_b64_tr_b16 v[94:95], v14 offset:1024
    ds_read_b64_tr_b16 v[96:97], v15 offset:0
    ds_read_b64_tr_b16 v[98:99], v15 offset:1024
    ds_read_b64_tr_b16 v[132:133], v14 offset:8192
    ds_read_b64_tr_b16 v[134:135], v14 offset:9216
    ds_read_b64_tr_b16 v[136:137], v15 offset:8192
    ds_read_b64_tr_b16 v[138:139], v15 offset:9216
    s_waitcnt lgkmcnt(8)
    v_add_f32 v188, v188, v172
    v_rcp_f32 v2, v188
    v_add_f32 v180, v180, v164
    v_add_f32 v181, v181, v165
    v_add_f32 v182, v182, v166
    v_add_f32 v183, v183, v167
    v_add_f32 v184, v184, v168
    v_add_f32 v185, v185, v169
    v_add_f32 v186, v186, v170
    v_add_f32 v187, v187, v171
    v_mul_f32 v180, v180, v2
    v_mul_f32 v181, v181, v2
    v_mul_f32 v182, v182, v2
    v_mul_f32 v183, v183, v2
    v_mul_f32 v184, v184, v2
    v_mul_f32 v185, v185, v2
    v_mul_f32 v186, v186, v2
    v_mul_f32 v187, v187, v2
    v_cvt_pk_bf16_f32 v164, v180, v181
    v_cvt_pk_bf16_f32 v165, v182, v183
    v_cvt_pk_bf16_f32 v166, v184, v185
    v_cvt_pk_bf16_f32 v167, v186, v187
    buffer_store_dwordx4 v[164:167], v6, s[16:19], s79 offen sc1
    s_add_u32 m0, s6, 57344
    s_add_u32 s64, s82, 32768
    buffer_load_dwordx4 v10, s[24:27], s64 offen lds
    s_add_u32 m0, s6, 32768
    s_add_u32 s64, s82, 49152
    buffer_load_dwordx4 v10, s[24:27], s64 offen lds
    s_add_u32 m0, s6, 40960
    s_add_u32 s64, s82, 65536
    buffer_load_dwordx4 v10, s[24:27], s64 offen lds
    s_add_u32 m0, s6, 122880
    s_add_u32 s64, s82, 81920
    buffer_load_dwordx4 v10, s[24:27], s64 offen lds
    s_add_u32 m0, s6, 98304
    s_add_u32 s64, s82, 98304
    buffer_load_dwordx4 v10, s[24:27], s64 offen lds
    s_add_u32 m0, s6, 106496
    s_add_u32 s64, s82, 114688
    buffer_load_dwordx4 v10, s[24:27], s64 offen lds
    v_subrev_u32 v3, 0x21800000, v188
    v_mul_f32 v2, 0, v180
    s_mov_b32 s64, 0x3c000000
    v_cmp_gt_u32 s[66:67], s64, v3
    v_fmac_f32 v2, 0, v181
    v_fmac_f32 v2, 0, v182
    v_fmac_f32 v2, 0, v183
    v_fmac_f32 v2, 0, v184
    v_fmac_f32 v2, 0, v185
    v_fmac_f32 v2, 0, v186
    v_fmac_f32 v2, 0, v187
    v_cmp_eq_f32 vcc, 0, v2
    s_and_b64 vcc, vcc, s[66:67]
    s_cmp_eq_u64 vcc, exec
    s_cbranch_scc0 L_slow_25
L_back_26:
    ds_read_b64_tr_b16 v[140:141], v14 offset:16384
    ds_read_b64_tr_b16 v[142:143], v14 offset:17408
    ds_read_b64_tr_b16 v[144:145], v15 offset:16384
    ds_read_b64_tr_b16 v[146:147], v15 offset:17408
    s_waitcnt lgkmcnt(8)
    v_mfma_f32_32x32x16_bf16 v[100:115], v[92:95], v[44:47], v[100:115]
    v_mfma_f32_32x32x16_bf16 v[116:131], v[96:99], v[44:47], v[116:131]
    ds_read_b64_tr_b16 v[92:93], v14 offset:24576
    ds_read_b64_tr_b16 v[94:95], v14 offset:25600
    ds_read_b64_tr_b16 v[96:97], v15 offset:24576
    ds_read_b64_tr_b16 v[98:99], v15 offset:25600
    s_waitcnt lgkmcnt(8)
    v_mfma_f32_32x32x16_bf16 v[100:115], v[132:135], v[48:51], v[100:115]
    v_mfma_f32_32x32x16_bf16 v[116:131], v[136:139], v[48:51], v[116:131]
    v_add_u32 v14, 0x10000, v14
    v_add_u32 v15, 0x10000, v15
    ds_read_b64_tr_b16 v[132:133], v14 offset:0
    ds_read_b64_tr_b16 v[134:135], v14 offset:1024
    ds_read_b64_tr_b16 v[136:137], v15 offset:0
    ds_read_b64_tr_b16 v[138:139], v15 offset:1024
    s_waitcnt lgkmcnt(8)
    v_mfma_f32_32x32x16_bf16 v[100:115], v[140:143], v[60:63], v[100:115]
    v_mfma_f32_32x32x16_bf16 v[116:131], v[144:147], v[60:63], v[116:131]
    s_waitcnt vmcnt(6)
    v_mov_b32 v2, 1
    v_mov_b32 v3, 0
    s_mov_b64 exec, 1
    buffer_store_dword v2, v3, s[16:19], s78 offen sc1
    s_mov_b64 exec, -1
    ds_read_b64_tr_b16 v[140:141], v14 offset:8192
    ds_read_b64_tr_b16 v[142:143], v14 offset:9216
    ds_read_b64_tr_b16 v[144:145], v15 offset:8192
    ds_read_b64_tr_b16 v[146:147], v15 offset:9216
    s_waitcnt lgkmcnt(8)
    v_mfma_f32_32x32x16_bf16 v[100:115], v[92:95], v[64:67], v[100:115]
    v_mfma_f32_32x32x16_bf16 v[116:131], v[96:99], v[64:67], v[116:131]
    v_add_u32 v14, 0x10000, v14
    v_add_u32 v15, 0x10000, v15
    ds_read_b64_tr_b16 v[92:93], v14 offset:0
    ds_read_b64_tr_b16 v[94:95], v14 offset:1024
    ds_read_b64_tr_b16 v[96:97], v15 offset:0
    ds_read_b64_tr_b16 v[98:99], v15 offset:1024
    s_waitcnt lgkmcnt(8)
    v_mfma_f32_32x32x16_bf16 v[100:115], v[132:135], v[52:55], v[100:115]
    v_mfma_f32_32x32x16_bf16 v[116:131], v[136:139], v[52:55], v[116:131]
    s_waitcnt lgkmcnt(4)
    v_mfma_f32_32x32x16_bf16 v[100:115], v[140:143], v[56:59], v[100:115]
    v_mfma_f32_32x32x16_bf16 v[116:131], v[144:147], v[56:59], v[116:131]
    s_waitcnt lgkmcnt(0)
    v_mfma_f32_32x32x16_bf16 v[100:115], v[92:95], v[40:43], v[100:115]
    v_mfma_f32_32x32x16_bf16 v[116:131], v[96:99], v[40:43], v[116:131]
    v_add_u32 v14, 0xffff0000, v14
    v_add_u32 v15, 0xffff0000, v15
    s_cmp_eq_u32 s63, 3
    s_cbranch_scc1 L_p3sk_27
    ds_read_b64_tr_b16 v[92:93], v14 offset:16384
    ds_read_b64_tr_b16 v[94:95], v14 offset:17408
    ds_read_b64_tr_b16 v[96:97], v15 offset:16384
    ds_read_b64_tr_b16 v[98:99], v15 offset:17408
    ds_read_b64_tr_b16 v[132:133], v14 offset:24576
    ds_read_b64_tr_b16 v[134:135], v14 offset:25600
    ds_read_b64_tr_b16 v[136:137], v15 offset:24576
    ds_read_b64_tr_b16 v[138:139], v15 offset:25600
    s_waitcnt lgkmcnt(4)
    v_mfma_f32_32x32x16_bf16 v[100:115], v[92:95], v[68:71], v[100:115]
    v_mfma_f32_32x32x16_bf16 v[116:131], v[96:99], v[68:71], v[116:131]
    s_waitcnt lgkmcnt(0)
    v_mfma_f32_32x32x16_bf16 v[100:115], v[132:135], v[72:75], v[100:115]
    v_mfma_f32_32x32x16_bf16 v[116:131], v[136:139], v[72:75], v[116:131]
L_p3sk_27:
    s_cmp_eq_u32 s58, 6
    s_cbranch_scc0 L_pollo_28_ok
L_pollo_28:
    buffer_load_dword v12, v20, s[16:19], s81 offen sc1
    s_waitcnt vmcnt(0)
    v_cmp_eq_u32 vcc, 1, v12
    s_cmp_eq_u64 vcc, exec
    s_cbranch_scc1 L_pollo_28_ok
    s_sleep 2
    s_branch L_pollo_28
L_pollo_28_ok:
    s_waitcnt vmcnt(1)
    s_barrier
    buffer_load_dwordx4 v[196:199], v6, s[16:19], s80 offen offset:0 sc1
    buffer_load_dwordx4 v[200:203], v6, s[16:19], s80 offen offset:1024 sc1
    buffer_load_dwordx4 v[204:207], v6, s[16:19], s80 offen offset:2048 sc1
    buffer_load_dwordx4 v[208:211], v6, s[16:19], s80 offen offset:3072 sc1
    s_add_u32 s80, s80, 4096
    buffer_load_dwordx4 v[212:215], v6, s[16:19], s80 offen offset:0 sc1
    buffer_load_dwordx4 v[216:219], v6, s[16:19], s80 offen offset:1024 sc1
    buffer_load_dwordx4 v[220:223], v6, s[16:19], s80 offen offset:2048 sc1
    buffer_load_dwordx4 v[224:227], v6, s[16:19], s80 offen offset:3072 sc1
    ds_read_b64_tr_b16 v[92:93], v14 offset:49152
    ds_read_b64_tr_b16 v[94:95], v14 offset:50176
    ds_read_b64_tr_b16 v[96:97], v15 offset:49152
    ds_read_b64_tr_b16 v[98:99], v15 offset:50176
    v_add_u32 v14, 0xffff0000, v14
    v_add_u32 v15, 0xffff0000, v15
    ds_read_b64_tr_b16 v[132:133], v14 offset:49152
    ds_read_b64_tr_b16 v[134:135], v14 offset:50176
    ds_read_b64_tr_b16 v[136:137], v15 offset:49152
    ds_read_b64_tr_b16 v[138:139], v15 offset:50176
    ds_read_b64_tr_b16 v[140:141], v14 offset:57344
    ds_read_b64_tr_b16 v[142:143], v14 offset:58368
    ds_read_b64_tr_b16 v[144:145], v15 offset:57344
    ds_read_b64_tr_b16 v[146:147], v15 offset:58368
    s_waitcnt vmcnt(7) lgkmcnt(8)
    v_mfma_f32_32x32x16_bf16 v[100:115], v[92:95], v[196:199], v[100:115]
    v_mfma_f32_32x32x16_bf16 v[116:131], v[96:99], v[196:199], v[116:131]
    ds_read_b64_tr_b16 v[92:93], v14 offset:32768
    ds_read_b64_tr_b16 v[94:95], v14 offset:33792
    ds_read_b64_tr_b16 v[96:97], v15 offset:32768
    ds_read_b64_tr_b16 v[98:99], v15 offset:33792
    s_waitcnt vmcnt(6) lgkmcnt(8)
    v_mfma_f32_32x32x16_bf16 v[100:115], v[132:135], v[200:203], v[100:115]
    v_mfma_f32_32x32x16_bf16 v[116:131], v[136:139], v[200:203], v[116:131]
    ds_read_b64_tr_b16 v[132:133], v14 offset:40960
    ds_read_b64_tr_b16 v[134:135], v14 offset:41984
    ds_read_b64_tr_b16 v[136:137], v15 offset:40960
    ds_read_b64_tr_b16 v[138:139], v15 offset:41984
    s_waitcnt vmcnt(5) lgkmcnt(8)
    v_mfma_f32_32x32x16_bf16 v[100:115], v[140:143], v[204:207], v[100:115]
    v_mfma_f32_32x32x16_bf16 v[116:131], v[144:147], v[204:207], v[116:131]
    v_add_u32 v14, 0x10000, v14
    v_add_u32 v15, 0x10000, v15
    ds_read_b64_tr_b16 v[140:141], v14 offset:57344
    ds_read_b64_tr_b16 v[142:143], v14 offset:58368
    ds_read_b64_tr_b16 v[144:145], v15 offset:57344
    ds_read_b64_tr_b16 v[146:147], v15 offset:58368
    s_waitcnt vmcnt(4) lgkmcnt(8)
    v_mfma_f32_32x32x16_bf16 v[100:115], v[92:95], v[208:211], v[100:115]
    v_mfma_f32_32x32x16_bf16 v[116:131], v[96:99], v[208:211], v[116:131]
    ds_read_b64_tr_b16 v[92:93], v14 offset:32768
    ds_read_b64_tr_b16 v[94:95], v14 offset:33792
    ds_read_b64_tr_b16 v[96:97], v15 offset:32768
    ds_read_b64_tr_b16 v[98:99], v15 offset:33792
    s_waitcnt vmcnt(3) lgkmcnt(8)
    v_mfma_f32_32x32x16_bf16 v[100:115], v[132:135], v[212:215], v[100:115]
    v_mfma_f32_32x32x16_bf16 v[116:131], v[136:139], v[212:215], v[116:131]
    ds_read_b64_tr_b16 v[132:133], v14 offset:40960
    ds_read_b64_tr_b16 v[134:135], v14 offset:41984
    ds_read_b64_tr_b16 v[136:137], v15 offset:40960
    ds_read_b64_tr_b16 v[138:139], v15 offset:41984
    s_waitcnt vmcnt(2) lgkmcnt(8)
    v_mfma_f32_32x32x16_bf16 v[100:115], v[140:143], v[216:219], v[100:115]
    v_mfma_f32_32x32x16_bf16 v[116:131], v[144:147], v[216:219], v[116:131]
    s_waitcnt vmcnt(1) lgkmcnt(4)
    v_mfma_f32_32x32x16_bf16 v[100:115], v[92:95], v[220:223], v[100:115]
    v_mfma_f32_32x32x16_bf16 v[116:131], v[96:99], v[220:223], v[116:131]
    s_waitcnt vmcnt(0) lgkmcnt(0)
    v_mfma_f32_32x32x16_bf16 v[100:115], v[132:135], v[224:227], v[100:115]
    v_mfma_f32_32x32x16_bf16 v[116:131], v[136:139], v[224:227], v[116:131]
    s_nop 11
    ds_write_b128 v17, v[108:111] offset:0
    ds_write_b128 v17, v[112:115] offset:1024
    ds_write_b128 v18, v[116:119] offset:0
    ds_write_b128 v18, v[120:123] offset:1024
    ds_write_b128 v19, v[124:127] offset:0
    ds_write_b128 v19, v[128:131] offset:1024
    v_add_f32 v100, v100, v32
    v_add_f32 v101, v101, v33
    v_add_f32 v102, v102, v34
    v_add_f32 v103, v103, v35
    v_add_f32 v104, v104, v36
    v_add_f32 v105, v105, v37
    v_add_f32 v106, v106, v38
    v_add_f32 v107, v107, v39
    s_waitcnt lgkmcnt(0)
    s_barrier
    ds_read_b128 v[164:167], v16 offset:0
    ds_read_b128 v[168:171], v16 offset:1024
    ds_read_b128 v[172:175], v16 offset:2048
    ds_read_b128 v[176:179], v16 offset:3072
    ds_read_b128 v[180:183], v16 offset:4096
    ds_read_b128 v[184:187], v16 offset:5120
    s_waitcnt lgkmcnt(4)
    v_add_f32 v100, v100, v164
    v_add_f32 v101, v101, v165
    v_add_f32 v102, v102, v166
    v_add_f32 v103, v103, v167
    v_add_f32 v104, v104, v168
    v_add_f32 v105, v105, v169
    v_add_f32 v106, v106, v170
    v_add_f32 v107, v107, v171
    s_waitcnt lgkmcnt(2)
    v_add_f32 v100, v100, v172
    v_add_f32 v101, v101, v173
    v_add_f32 v102, v102, v174
    v_add_f32 v103, v103, v175
    v_add_f32 v104, v104, v176
    v_add_f32 v105, v105, v177
    v_add_f32 v106, v106, v178
    v_add_f32 v107, v107, v179
    s_waitcnt lgkmcnt(0)
    v_add_f32 v100, v100, v180
    v_add_f32 v101, v101, v181
    v_add_f32 v102, v102, v182
    v_add_f32 v103, v103, v183
    v_add_f32 v104, v104, v184
    v_add_f32 v105, v105, v185
    v_add_f32 v106, v106, v186
    v_add_f32 v107, v107, v187
    v_cvt_pk_bf16_f32 v24, v100, v101
    v_cvt_pk_bf16_f32 v25, v102, v103
    v_cvt_pk_bf16_f32 v26, v104, v105
    v_cvt_pk_bf16_f32 v27, v106, v107
    s_nop 1
    v_permlane32_swap_b32 v24, v26
    v_permlane32_swap_b32 v25, v27
    buffer_store_dwordx4 v[24:27], v11, s[28:31], 0 offen
L_end:
    s_endpgm
L_slow_25:
    s_waitcnt vmcnt(0)
    s_lshl_b32 s64, s59, 6
    s_lshl_b32 s65, s60, 3
    s_add_u32 s64, s64, s65
    s_lshl_b32 s65, s61, 1
    s_add_u32 s64, s64, s65
    s_add_u32 s64, s64, s62
    s_lshl_b32 s64, s64, 10
    buffer_load_dwordx4 v[212:215], v6, s[16:19], s64 offen sc1
    s_lshl_b32 s65, s59, 17
    s_add_u32 s65, s65, 2097152
    s_lshl_b32 s64, s62, 16
    v_subrev_u32 v5, s64, v9
    v_mov_b32 v4, 0xff800000
    s_mov_b32 s64, s65
    s_mov_b32 s66, 64
L_s1_29:
    buffer_load_dwordx4 v[216:219], v6, s[16:19], s64 offen sc1
    s_waitcnt vmcnt(0)
    v_mfma_f32_32x32x16_bf16 v[164:179], v[216:219], v[212:215], 0
    s_add_u32 s64, s64, 2048
    s_sub_u32 s66, s66, 1
    s_nop 15
    v_max3_f32 v4, v4, v164, v165
    v_max3_f32 v4, v4, v166, v167
    v_max3_f32 v4, v4, v168, v169
    v_max3_f32 v4, v4, v170, v171
    v_max3_f32 v4, v4, v172, v173
    v_max3_f32 v4, v4, v174, v175
    v_max3_f32 v4, v4, v176, v177
    v_max3_f32 v4, v4, v178, v179
    s_cmp_lg_u32 s66, 0
    s_cbranch_scc1 L_s1_29
    v_mov_b32 v2, v4
    s_nop 1
    v_permlane32_swap_b32 v4, v2
    s_mov_b32 s64, s65
    s_mov_b32 s66, 64
    v_max_f32 v4, v4, v2
    v_mov_b32 v196, 0
    v_mov_b32 v197, 0
    v_mov_b32 v198, 0
    v_mov_b32 v199, 0
    v_mov_b32 v200, 0
    v_mov_b32 v201, 0
    v_mov_b32 v202, 0
    v_mov_b32 v203, 0
    v_mov_b32 v204, 0
    v_mov_b32 v205, 0
    v_mov_b32 v206, 0
    v_mov_b32 v207, 0
    v_mov_b32 v208, 0
    v_mov_b32 v209, 0
    v_mov_b32 v210, 0
    v_mov_b32 v211, 0
L_s2_30:
    buffer_load_dwordx4 v[216:219], v6, s[16:19], s64 offen sc1
    s_mov_b64 exec, s[74:75]
    buffer_load_dwordx4 v[148:151], v5, s[16:19], s64 offen offset:1024 sc1
    buffer_load_dwordx4 v[152:155], v5, s[16:19], s64 offen offset:1536 sc1
    s_mov_b64 exec, -1
    s_waitcnt vmcnt(0)
    v_mfma_f32_32x32x16_bf16 v[164:179], v[216:219], v[212:215], 0
    s_add_u32 s64, s64, 2048
    s_sub_u32 s66, s66, 1
    s_nop 15
    v_sub_f32 v164, v164, v4
    v_sub_f32 v165, v165, v4
    v_sub_f32 v166, v166, v4
    v_sub_f32 v167, v167, v4
    v_sub_f32 v168, v168, v4
    v_sub_f32 v169, v169, v4
    v_sub_f32 v170, v170, v4
    v_sub_f32 v171, v171, v4
    v_sub_f32 v172, v172, v4
    v_sub_f32 v173, v173, v4
    v_sub_f32 v174, v174, v4
    v_sub_f32 v175, v175, v4
    v_sub_f32 v176, v176, v4
    v_sub_f32 v177, v177, v4
    v_sub_f32 v178, v178, v4
    v_sub_f32 v179, v179, v4
    v_exp_f32 v164, v164
    v_exp_f32 v165, v165
    v_exp_f32 v166, v166
    v_exp_f32 v167, v167
    v_exp_f32 v168, v168
    v_exp_f32 v169, v169
    v_exp_f32 v170, v170
    v_exp_f32 v171, v171
    v_exp_f32 v172, v172
    v_exp_f32 v173, v173
    v_exp_f32 v174, v174
    v_exp_f32 v175, v175
    v_exp_f32 v176, v176
    v_exp_f32 v177, v177
    v_exp_f32 v178, v178
    v_exp_f32 v179, v179
    s_nop 1
    v_smfmac_f32_32x32x32_bf16 v[196:211], v[148:151], v[164:171], v7
    v_smfmac_f32_32x32x32_bf16 v[196:211], v[152:155], v[172:179], v7
    s_cmp_lg_u32 s66, 0
    s_cbranch_scc1 L_s2_30
    s_nop 15
    v_rcp_f32 v2, v204
    s_nop 0
    v_mul_f32 v196, v196, v2
    v_mul_f32 v197, v197, v2
    v_mul_f32 v198, v198, v2
    v_mul_f32 v199, v199, v2
    v_mul_f32 v200, v200, v2
    v_mul_f32 v201, v201, v2
    v_mul_f32 v202, v202, v2
    v_mul_f32 v203, v203, v2
    v_cvt_pk_bf16_f32 v164, v196, v197
    v_cvt_pk_bf16_f32 v165, v198, v199
    v_cvt_pk_bf16_f32 v166, v200, v201
    v_cvt_pk_bf16_f32 v167, v202, v203
    buffer_store_dwordx4 v[164:167], v6, s[16:19], s79 offen sc1
    s_waitcnt vmcnt(0)
    s_branch L_back_26
.fill 8192, 4, 0xbf800000
.section .rodata,"a"
.p2align 6
.amdhsa_kernel parallel_sum__softmax_full_mha__dense_activation_gelu__prompt_kernel
  .amdhsa_next_free_vgpr 256
  .amdhsa_next_free_sgpr 102
  .amdhsa_accum_offset 256
  .amdhsa_group_segment_fixed_size 0
  .amdhsa_kernarg_size 88
  .amdhsa_user_sgpr_count 2
  .amdhsa_user_sgpr_kernarg_segment_ptr 1
  .amdhsa_system_sgpr_workgroup_id_x 1
  .amdhsa_float_denorm_mode_32 3
  .amdhsa_float_denorm_mode_16_64 3
.end_amdhsa_kernel
```
